```python
import torch

def _softmax(x, axis=-1):
    return torch.softmax(x, dim=axis)
def _gelu(x):
    return torch.nn.functional.gelu(x, approximate="tanh")
def _silu(x):
    return torch.nn.functional.silu(x)
def _sigmoid(x):
    return torch.sigmoid(x)
def _layernorm(x, axis=-1, eps=1e-5):
    m = x.mean(dim=axis, keepdim=True)
    v = x.var(dim=axis, keepdim=True, unbiased=False)
    return (x - m) / torch.sqrt(v + eps)
def _scatter_add(tgt, idx, src, axis=0):
    return tgt.clone().index_add_(axis, idx, src)
def _segment_sum(src, seg, n):
    out = torch.zeros((n,) + src.shape[1:], dtype=src.dtype)
    return out.index_add_(0, seg, src)
def _pad(x, pw):
    flat = tuple(v for pair in reversed(pw) for v in pair)
    return torch.nn.functional.pad(x, flat)

kernel_name = 'parallel_sum__gqa_block_cached__dense_activation_squared_relu__decode'

def setup_inputs():

    _w = (lambda a: (lambda t: t.to(torch.bfloat16) if t.is_floating_point() else t)(torch.as_tensor(a)))
    def _A_setup():
        B, Sq, D = 8, 1, 1024
        Hq, Hkv, Sk, Dh = 32, 4, 4096, 128
        assert Hq % Hkv == 0, (Hq, Hkv)
        return {
            "x": _w((lambda *s: torch.randn(*s, dtype=torch.bfloat16) * 0.05)(B, Sq, D)),
            "k_cache": _w((lambda *s: torch.randn(*s, dtype=torch.bfloat16) * 1.6)(B, Hkv, Sk, Dh)),
            "v_cache": _w((lambda *s: torch.randn(*s, dtype=torch.bfloat16) * 3.2)(B, Hkv, Sk, Dh)),
            "wq": _w((lambda *s: torch.randn(*s, dtype=torch.bfloat16) * 1.6)(D, Hq * Dh) * (D ** -0.5)),
            "wo": _w((lambda *s: torch.randn(*s, dtype=torch.bfloat16) * 3.2)(Hq * Dh, D) * ((Hq * Dh) ** -0.5)),
        }
    _A_in = _A_setup()

    def _B_setup():
        B, S, D, F = 8, 1, 1024, 3584
        return {
            "x": _w((lambda *s: torch.randn(*s, dtype=torch.bfloat16) * 0.05)(B, S, D)),
            "w1": _w((lambda *s: torch.randn(*s, dtype=torch.bfloat16) * 0.05)(D, F)),
            "b1": _w((lambda *s: torch.randn(*s, dtype=torch.bfloat16) * 0.4)(F)),
            "w2": _w((lambda *s: torch.randn(*s, dtype=torch.bfloat16) * 0.05)(F, D)),
            "b2": _w((lambda *s: torch.randn(*s, dtype=torch.bfloat16) * 3.2)(D)),
        }
    _B_in = _B_setup()

    return {
        "A_x": _A_in["x"],
        "A_k_cache": _A_in["k_cache"],
        "A_v_cache": _A_in["v_cache"],
        "A_wq": _A_in["wq"],
        "A_wo": _A_in["wo"],
        "B_x": _B_in["x"],
        "B_w1": _B_in["w1"],
        "B_b1": _B_in["b1"],
        "B_w2": _B_in["w2"],
        "B_b2": _B_in["b2"],
    }

def reference(A_x, A_k_cache, A_v_cache, A_wq, A_wo, B_x, B_w1, B_b1, B_w2, B_b2):
    def _A_ref(x, k_cache, v_cache, wq, wo):
        B, Sq, D = x.shape
        Hq, Dh = 32, 128
        Hkv = k_cache.shape[1]
        rep = Hq // Hkv
        q = (lambda x, *d: x.permute(*d))((x @ wq).reshape(B, Sq, Hq, Dh), 0, 2, 1, 3)
        k = (lambda x, n, axis: torch.repeat_interleave(x, n, dim=axis))(k_cache, rep, axis=1)
        v = (lambda x, n, axis: torch.repeat_interleave(x, n, dim=axis))(v_cache, rep, axis=1)
        scores = torch.einsum("bhqd,bhkd->bhqk", q, k) * (Dh ** -0.5)
        p = _softmax(scores, axis=-1)
        o = torch.einsum("bhqk,bhkd->bhqd", p, v)
        return (lambda x, *d: x.permute(*d))(o, 0, 2, 1, 3).reshape(B, Sq, Hq * Dh) @ wo

    def _B_ref(x, w1, b1, w2, b2):
        h = torch.einsum("bsd,df->bsf", x, w1) + b1
        zero = torch.zeros_like(h)
        r = torch.where(h > zero, h, zero)
        h = r * r
        out = torch.einsum("bsf,fd->bsd", h, w2) + b2
        return out

    x = A_x
    xn = _layernorm(x, axis=-1)
    return x + _A_ref(xn, A_k_cache, A_v_cache, A_wq, A_wo) + _B_ref(xn, B_w1, B_b1, B_w2, B_b2)
```

```asm
; @launch grid=(256,1,1) block=(512,1,1) lds=150336
.amdgcn_target "amdgcn-amd-amdhsa--gfx950"
.text
.globl parallel_sum__gqa_block_cached__dense_activation_squared_relu__decode_kernel
.p2align 8
.type parallel_sum__gqa_block_cached__dense_activation_squared_relu__decode_kernel,@function
parallel_sum__gqa_block_cached__dense_activation_squared_relu__decode_kernel:
L_beg:
    s_cmp_ge_u32 s2, 256
    s_cbranch_scc1 L_end

    s_load_dwordx2 s[20:21], s[0:1], 24
    v_lshlrev_b32 v1, 4, v0
    v_lshrrev_b32 v50, 3, v0
    s_and_b32 s4, s2, 7
    v_readfirstlane_b32 s64, v1
    s_lshl_b32 s4, s4, 5
    s_lshr_b32 s2, s2, 3
    s_or_b32 s2, s2, s4
    s_lshr_b32 s5, s2, 6
    s_and_b32 s4, s2, 63
    s_bitcmp1_b32 s64, 12
    s_cbranch_scc1 L_hstub

    s_load_dwordx2 s[12:13], s[0:1], 8
    v_and_b32 v51, 6, v50
    v_xor_b32 v51, v51, v0
    v_and_b32 v51, 7, v51
    v_lshlrev_b32 v51, 4, v51
    v_lshl_add_u32 v3, v50, 13, v51
    s_lshl_b32 s58, s5, 14
    s_or_b32 s58, s58, s4
    s_lshl_b32 s58, s58, 7
    s_mov_b32 s23, 0x20000
    s_lshl_b32 s22, s23, 6
    s_lshl_b32 s68, s23, 1

    s_or_b32 s9, s2, s64
    s_bfe_u32 s8, s9, 196608
    s_lshl_b32 s8, s8, 12
    s_lshl_b32 s9, s8, 6
    s_or_b32 s58, s58, s9
    s_or_b32 s8, s8, s64
    s_mov_b32 m0, s8
    s_waitcnt lgkmcnt(0)
    buffer_load_dwordx4 v3, s[20:23], s58 offen nt lds
    s_xor_b32 m0, s8, 4096
    s_xor_b32 s53, s58, 262144
    buffer_load_dwordx4 v3, s[20:23], s53 offen nt lds
    s_xor_b32 m0, s8, 8192
    s_xor_b32 s53, s58, 524288
    buffer_load_dwordx4 v3, s[20:23], s53 offen nt lds
    s_xor_b32 m0, s8, 12288
    s_xor_b32 s53, s58, 786432
    buffer_load_dwordx4 v3, s[20:23], s53 offen nt lds
    s_xor_b32 m0, s8, 16384
    s_xor_b32 s53, s58, 1048576
    buffer_load_dwordx4 v3, s[20:23], s53 offen nt lds
    s_xor_b32 m0, s8, 20480
    s_xor_b32 s53, s58, 1310720
    buffer_load_dwordx4 v3, s[20:23], s53 offen nt lds
    s_xor_b32 m0, s8, 24576
    s_xor_b32 s53, s58, 1572864
    buffer_load_dwordx4 v3, s[20:23], s53 offen nt lds
    s_barrier
    s_branch L_s2
L_hstub:
    s_load_dwordx2 s[24:25], s[0:1], 0

    v_and_b32 v52, 0x1f0, v1
    v_and_b32 v50, 0xe00, v1
    v_lshl_add_u32 v36, v50, 2, v52
    v_and_b32 v50, 60, v0
    v_add_u32 v50, 150272, v50
    v_mov_b32 v13, 0
    ds_write_b32 v50, v13
    s_mov_b32 s27, 0x20000
    s_lshr_b32 s26, s27, 3
    s_lshl_b32 s68, s5, 9
    s_xor_b32 s69, s68, 512
    s_xor_b32 s70, s68, 1024
    s_xor_b32 s71, s68, 1536

    s_waitcnt lgkmcnt(0)
    buffer_load_dwordx4 v[64:67], v36, s[24:27], s68 offen
    buffer_load_dwordx4 v[68:71], v36, s[24:27], s69 offen
    buffer_load_dwordx4 v[72:75], v36, s[24:27], s70 offen
    buffer_load_dwordx4 v[76:79], v36, s[24:27], s71 offen

    s_getpc_b64 s[6:7]
L_pf:
    s_lshr_b32 s8, s64, 3
    s_and_b32 s9, s2, 31
    s_lshl_b32 s9, s9, 9
    s_add_u32 s8, s8, s9
    s_min_u32 s8, s8, L_end-L_pf+384
    s_sub_u32 s8, s8, 512
    s_add_u32 s6, s6, s8
    s_addc_u32 s7, s7, 0

    s_add_u32 s10, s8, 16384
    s_min_u32 s10, s10, L_end-L_pf-128
    s_sub_u32 s10, s10, s8
    s_add_u32 s11, s10, 128
    s_add_u32 s10, s10, 64
    s_load_dword s8, s[6:7], 64
    s_load_dword s9, s[6:7], 128
    s_load_dword s10, s[6:7], s10
    s_load_dword s11, s[6:7], s11

    s_load_dwordx2 s[36:37], s[0:1], 96
    s_load_dwordx2 s[40:41], s[0:1], 56
    s_load_dwordx4 s[44:47], s[0:1], 72
    s_load_dwordx2 s[16:17], s[0:1], 88

    s_barrier
    s_branch L_helper
L_s2:

    s_load_dwordx2 s[24:25], s[0:1], 48
    s_load_dwordx2 s[16:17], s[0:1], 16
    s_load_dwordx2 s[32:33], s[0:1], 32
    s_load_dwordx2 s[28:29], s[0:1], 64

    s_load_dwordx2 s[36:37], s[0:1], 96
    s_mov_b32 s75, 0

    s_lshr_b32 s3, s64, 10
    v_and_b32 v0, 63, v0
    v_and_b32 v62, 15, v0
    v_lshrrev_b32 v63, 4, v0
    v_mul_u32_u24 v50, 7168, v50
    v_add_u32 v4, v50, v51

    s_bfe_u32 s6, s2, 0x10005
    s_bfe_u32 s7, s2, 0x10006
    s_lshl1_add_u32 s6, s6, s7
    s_xor_b32 s6, s6, 2
    s_lshr_b32 s7, s2, 7
    s_lshl_b32 s7, s7, 5
    s_and_b32 s73, s2, 31
    s_or_b32 s7, s7, s73
    s_xor_b32 s73, s6, 1
    s_lshl_b32 s73, s73, 6
    s_or_b32 s73, s73, s7
    s_lshr_b32 s72, s7, 3
    s_lshl2_add_u32 s72, s72, s6
    s_and_b32 s7, s2, 7
    s_lshl3_add_u32 s72, s72, s7

    s_lshr_b32 s7, s2, 5
    s_mul_i32 s6, s7, 0
    s_add_u32 s6, s6, s2
    s_and_b32 s6, s6, 31
    s_lshl3_add_u32 s73, s6, s7
    s_lshr_b32 s59, s72, 3
    s_lshl_b32 s59, s59, 20
    s_and_b32 s70, s72, 7
    s_lshl_b32 s70, s70, 14
    s_or_b32 s59, s59, s70

    s_and_b32 s70, s3, 1
    s_lshl_b32 s70, s70, 12
    s_add_u32 s59, s59, s70
    s_lshr_b32 s70, s3, 1
    s_lshl_b32 s70, s70, 13
    s_add_u32 s59, s59, s70

    s_and_b32 s70, s59, 1048576
    s_bcnt1_i32_b32 s70, s70
    s_and_b32 s70, s70, 1
    s_lshl_b32 s70, s70, 17
    s_or_b32 s57, 0, s70
    s_and_b32 s70, s59, 7340032
    s_bcnt1_i32_b32 s70, s70
    s_and_b32 s70, s70, 1
    s_lshl_b32 s70, s70, 18
    s_or_b32 s57, s57, s70
    s_and_b32 s70, s59, 26214400
    s_bcnt1_i32_b32 s70, s70
    s_and_b32 s70, s70, 1
    s_lshl_b32 s70, s70, 19
    s_or_b32 s57, s57, s70
    s_and_b32 s42, s57, 524288
    s_and_b32 s70, s59, 14680064
    s_bcnt1_i32_b32 s70, s70
    s_and_b32 s70, s70, 1
    s_lshl_b32 s70, s70, 17
    s_or_b32 s42, s42, s70
    s_and_b32 s70, s59, 3145728
    s_bcnt1_i32_b32 s70, s70
    s_and_b32 s70, s70, 1
    s_lshl_b32 s70, s70, 18
    s_or_b32 s42, s42, s70

    s_mov_b32 s14, 921600
    s_mov_b32 s15, 0x20000
    v_lshrrev_b32 v50, 1, v62
    v_and_b32 v51, 1, v50
    v_lshlrev_b32 v51, 10, v51
    v_bfe_u32 v50, v62, 2, 1
    v_lshl_add_u32 v51, v50, 8, v51
    v_lshrrev_b32 v50, 3, v62
    v_lshl_add_u32 v51, v50, 9, v51
    v_and_b32 v50, 1, v62
    v_lshl_add_u32 v51, v50, 6, v51
    v_lshl_add_u32 v2, v63, 4, v51
    s_lshl2_add_u32 s67, s3, 150272
    v_mov_b32 v12, s67

    s_add_u32 s12, s12, s59
    s_addc_u32 s13, s13, 0
    s_waitcnt vmcnt(6)
    s_xor_b32 m0, s8, 28672
    s_xor_b32 s53, s58, 1835008
    buffer_load_dwordx4 v3, s[20:23], s53 offen nt lds
    s_waitcnt vmcnt(6)
    s_xor_b32 s53, s42, 0
    buffer_load_dwordx4 v[64:67], v2, s[12:15], s53 offen offset:0 nt
    s_waitcnt vmcnt(6)
    s_xor_b32 s53, s42, 0
    buffer_load_dwordx4 v[68:71], v2, s[12:15], s53 offen offset:128 nt
    s_waitcnt vmcnt(6)
    s_xor_b32 s53, s42, 2048
    buffer_load_dwordx4 v[72:75], v2, s[12:15], s53 offen offset:0 nt
    s_waitcnt vmcnt(6)

    s_bfe_u32 s68, s2, 0x20003
    s_mul_i32 s68, s68, 1835008
    s_mov_b32 s26, 1835008

    s_mov_b32 s27, 0x20000
    s_mov_b32 s74, 0x400000
    v_lshlrev_b32 v1, 4, v62
    v_and_b32 v50, 1, v63
    v_lshl_add_u32 v1, v50, 8, v1
    v_lshrrev_b32 v50, 1, v63
    v_lshl_add_u32 v1, v50, 9, v1
    v_and_b32 v11, 3, v0
    v_lshlrev_b32 v11, 2, v11
    v_add_u32 v11, 150272, v11
    v_and_b32 v60, 7, v0
    v_lshlrev_b32 v52, 1, v63
    s_waitcnt lgkmcnt(0)
    s_add_u32 s24, s24, s68
    s_addc_u32 s25, s25, 0

    s_waitcnt vmcnt(5)
    s_xor_b32 s53, s42, 2048
    buffer_load_dwordx4 v[76:79], v2, s[12:15], s53 offen offset:128 nt

    s_add_u32 s16, s16, s59
    s_addc_u32 s17, s17, 0
    s_mov_b32 s18, 921600
    s_mov_b32 s19, 0x20000
    s_mov_b32 s54, 0x05040100
    s_mov_b32 s55, 0x07060302
    s_lshr_b32 s6, s73, 3
    s_and_b32 s7, s73, 7
    s_lshl_b32 s67, s7, 8
    s_lshl_b32 s68, s3, 14
    s_add_u32 s67, s67, s68
    s_lshl_b32 s68, s6, 18
    s_add_u32 s68, s68, s67
    s_add_u32 s32, s32, s68
    s_addc_u32 s33, s33, 0
    s_mov_b32 s34, 211200
    s_mov_b32 s35, 0x20000
    s_mul_i32 s68, s6, 229376
    s_add_u32 s68, s68, s67
    s_add_u32 s28, s28, s68
    s_addc_u32 s29, s29, 0
    s_lshl_b32 s68, s3, 13
    s_sub_u32 s56, 196608, s68
    s_add_u32 s30, s56, 6400
    s_mov_b32 s31, 0x20000
    s_lshl_b32 s65, s3, 11
    s_lshl_b32 s66, s3, 10

    s_waitcnt vmcnt(5)
    s_xor_b32 s53, s42, 131072
    buffer_load_dwordx4 v[80:83], v2, s[12:15], s53 offen offset:0 nt

    v_cmp_gt_u32 s[62:63], 8, v62
    v_lshlrev_b32 v51, 11, v63
    s_lshl_b32 s67, s3, 2
    v_and_b32 v50, 2, v63
    v_add_u32 v50, s67, v50
    v_xor_b32 v50, v50, v62
    v_lshl_add_u32 v5, v50, 4, v51
    v_xor_b32 v50, v52, v62
    v_lshl_add_u32 v50, v50, 4, v51
    s_and_b32 s67, s3, 1
    s_lshl_b32 s67, s67, 7
    v_xor_b32 v6, s67, v50
    s_lshr_b32 s67, s3, 1
    s_lshl_b32 s67, s67, 7
    v_xor_b32 v7, s67, v50
    v_mul_u32_u24 v50, 528, v60
    v_lshl_add_u32 v51, v63, 7, v50
    v_lshrrev_b32 v57, 3, v62
    v_lshl_add_u32 v51, v57, 6, v51
    s_mul_i32 s67, s3, 4224
    v_add_u32 v9, s67, v51
    v_mul_u32_u24 v51, 272, v60
    v_lshl_add_u32 v51, v57, 6, v51
    v_lshl_add_u32 v51, v63, 4, v51
    v_add_u32 v8, 143488, v51
    s_lshl_b32 s67, s3, 3
    s_add_u32 s67, s67, 150016
    v_lshl_add_u32 v10, v60, 5, s67

    s_waitcnt vmcnt(5)
    s_xor_b32 s53, s42, 131072
    buffer_load_dwordx4 v[84:87], v2, s[12:15], s53 offen offset:128 nt
    v_mov_b32 v0, 1
    ds_write_b32 v12, v0
    s_waitcnt vmcnt(5)
    s_xor_b32 s53, s42, 133120
    buffer_load_dwordx4 v[88:91], v2, s[12:15], s53 offen offset:0 nt
    s_waitcnt vmcnt(5)
    s_xor_b32 s53, s42, 133120
    buffer_load_dwordx4 v[92:95], v2, s[12:15], s53 offen offset:128 nt
    s_waitcnt vmcnt(5)
    s_xor_b32 s53, s42, 262144
    buffer_load_dwordx4 v[96:99], v2, s[12:15], s53 offen offset:0 nt
    s_waitcnt vmcnt(5)
    s_xor_b32 s53, s42, 262144
    buffer_load_dwordx4 v[100:103], v2, s[12:15], s53 offen offset:128 nt
    s_waitcnt vmcnt(5)
    s_xor_b32 s53, s42, 264192
    buffer_load_dwordx4 v[104:107], v2, s[12:15], s53 offen offset:0 nt
    s_waitcnt vmcnt(5)
    s_xor_b32 s53, s42, 264192
    buffer_load_dwordx4 v[108:111], v2, s[12:15], s53 offen offset:128 nt
    s_waitcnt vmcnt(5)
    s_xor_b32 s53, s42, 393216
    buffer_load_dwordx4 v[112:115], v2, s[12:15], s53 offen offset:0 nt
    s_waitcnt vmcnt(5)
    s_xor_b32 s53, s42, 393216
    buffer_load_dwordx4 v[116:119], v2, s[12:15], s53 offen offset:128 nt
    s_waitcnt vmcnt(5)
    s_xor_b32 s53, s42, 395264
    buffer_load_dwordx4 v[120:123], v2, s[12:15], s53 offen offset:0 nt
    s_waitcnt vmcnt(5)
    s_xor_b32 s53, s42, 395264
    buffer_load_dwordx4 v[124:127], v2, s[12:15], s53 offen offset:128 nt
    s_waitcnt vmcnt(5)
    s_xor_b32 s53, s57, 524288
    buffer_load_dwordx4 v[128:131], v2, s[12:15], s53 offen offset:0 nt
    s_waitcnt vmcnt(5)
    s_xor_b32 s53, s57, 524288
    buffer_load_dwordx4 v[132:135], v2, s[12:15], s53 offen offset:128 nt
    s_waitcnt vmcnt(5)
    s_xor_b32 s53, s57, 526336
    buffer_load_dwordx4 v[136:139], v2, s[12:15], s53 offen offset:0 nt
    s_waitcnt vmcnt(5)
    s_xor_b32 s53, s57, 526336
    buffer_load_dwordx4 v[140:143], v2, s[12:15], s53 offen offset:128 nt
    s_waitcnt vmcnt(5)
    s_xor_b32 s53, s57, 655360
    buffer_load_dwordx4 v[144:147], v2, s[12:15], s53 offen offset:0 nt
    v_max_u32 v0, 2, v0
    ds_write_b32 v12, v0
    s_waitcnt vmcnt(5)
    s_xor_b32 s53, s57, 655360
    buffer_load_dwordx4 v[148:151], v2, s[12:15], s53 offen offset:128 nt
    s_waitcnt vmcnt(5)
    s_xor_b32 s53, s57, 657408
    buffer_load_dwordx4 v[152:155], v2, s[12:15], s53 offen offset:0 nt
    s_waitcnt vmcnt(5)
    s_xor_b32 s53, s57, 657408
    buffer_load_dwordx4 v[156:159], v2, s[12:15], s53 offen offset:128 nt
    s_waitcnt vmcnt(5)
    s_xor_b32 s53, s57, 786432
    buffer_load_dwordx4 v[160:163], v2, s[12:15], s53 offen offset:0 nt
    s_waitcnt vmcnt(5)
    s_xor_b32 s53, s57, 786432
    buffer_load_dwordx4 v[164:167], v2, s[12:15], s53 offen offset:128 nt
    s_waitcnt vmcnt(5)
    s_xor_b32 s53, s57, 788480
    buffer_load_dwordx4 v[168:171], v2, s[12:15], s53 offen offset:0 nt
    s_waitcnt vmcnt(5)
    s_xor_b32 s53, s57, 788480
    buffer_load_dwordx4 v[172:175], v2, s[12:15], s53 offen offset:128 nt
    s_waitcnt vmcnt(5)
    s_xor_b32 s53, s57, 917504
    buffer_load_dwordx4 v[176:179], v2, s[12:15], s53 offen offset:0 nt
    s_waitcnt vmcnt(5)
    s_xor_b32 s53, s57, 917504
    buffer_load_dwordx4 v[180:183], v2, s[12:15], s53 offen offset:128 nt
    s_waitcnt vmcnt(5)
    s_xor_b32 s53, s57, 919552
    buffer_load_dwordx4 v[184:187], v2, s[12:15], s53 offen offset:0 nt
    s_waitcnt vmcnt(5)
    s_xor_b32 s53, s57, 919552
    buffer_load_dwordx4 v[188:191], v2, s[12:15], s53 offen offset:128 nt
    s_waitcnt vmcnt(5)
    s_xor_b32 s53, s42, 0
    buffer_load_dwordx4 v[208:211], v1, s[16:19], s53 offen nt
    s_waitcnt vmcnt(5)
    s_xor_b32 s53, s42, 1024
    buffer_load_dwordx4 v[212:215], v1, s[16:19], s53 offen nt
    s_waitcnt vmcnt(5)
    s_xor_b32 s53, s42, 2048
    buffer_load_dwordx4 v[216:219], v1, s[16:19], s53 offen nt
L_pw_1:

    ds_read_b32 v13, v11 offset:16
    s_sub_u32 s74, s74, 1
    s_cmp_lt_i32 s74, 0
    s_cbranch_scc1 L_pk_2
    s_waitcnt lgkmcnt(0)
    v_cmp_gt_u32 vcc, 2, v13
    s_cbranch_vccnz L_pw_1

L_pk_2:
    ds_read_b128 v[192:195], v8
    ds_read_b128 v[196:199], v8 offset:128
    s_waitcnt vmcnt(5)
    s_xor_b32 s53, s42, 3072
    buffer_load_dwordx4 v[220:223], v1, s[16:19], s53 offen nt
    s_waitcnt lgkmcnt(0)
    v_mfma_f32_16x16x32_bf16 v[32:35], v[64:67], v[192:195], 0
    v_mfma_f32_16x16x32_bf16 v[36:39], v[72:75], v[192:195], 0
    v_mfma_f32_16x16x32_bf16 v[40:43], v[80:83], v[192:195], 0
    v_mfma_f32_16x16x32_bf16 v[44:47], v[88:91], v[192:195], 0
    v_mfma_f32_16x16x32_bf16 v[32:35], v[68:71], v[196:199], v[32:35]
    v_mfma_f32_16x16x32_bf16 v[36:39], v[76:79], v[196:199], v[36:39]
    v_mfma_f32_16x16x32_bf16 v[40:43], v[84:87], v[196:199], v[40:43]
    v_mfma_f32_16x16x32_bf16 v[44:47], v[92:95], v[196:199], v[44:47]
    s_waitcnt vmcnt(5)
    s_xor_b32 s53, s42, 131072
    buffer_load_dwordx4 v[224:227], v1, s[16:19], s53 offen nt
    v_mfma_f32_16x16x32_bf16 v[48:51], v[96:99], v[192:195], 0
    v_mfma_f32_16x16x32_bf16 v[52:55], v[104:107], v[192:195], 0
    v_mfma_f32_16x16x32_bf16 v[56:59], v[112:115], v[192:195], 0
    v_mfma_f32_16x16x32_bf16 v[60:63], v[120:123], v[192:195], 0
    v_mfma_f32_16x16x32_bf16 v[48:51], v[100:103], v[196:199], v[48:51]
    v_mfma_f32_16x16x32_bf16 v[52:55], v[108:111], v[196:199], v[52:55]
    v_mfma_f32_16x16x32_bf16 v[56:59], v[116:119], v[196:199], v[56:59]
    v_mfma_f32_16x16x32_bf16 v[60:63], v[124:127], v[196:199], v[60:63]
    s_waitcnt vmcnt(5)
    s_xor_b32 s53, s42, 132096
    buffer_load_dwordx4 v[228:231], v1, s[16:19], s53 offen nt
    v_add_f32_dpp v16, v33, v32 row_ror:8 row_mask:0xf bank_mask:0x3
    v_add_f32_dpp v17, v35, v34 row_ror:8 row_mask:0xf bank_mask:0x3
    v_add_f32_dpp v18, v37, v36 row_ror:8 row_mask:0xf bank_mask:0x3
    v_add_f32_dpp v19, v39, v38 row_ror:8 row_mask:0xf bank_mask:0x3
    v_add_f32_dpp v20, v41, v40 row_ror:8 row_mask:0xf bank_mask:0x3
    v_add_f32_dpp v21, v43, v42 row_ror:8 row_mask:0xf bank_mask:0x3
    v_add_f32_dpp v22, v45, v44 row_ror:8 row_mask:0xf bank_mask:0x3
    v_add_f32_dpp v23, v47, v46 row_ror:8 row_mask:0xf bank_mask:0x3
    v_add_f32_dpp v16, v48, v49 row_ror:8 row_mask:0xf bank_mask:0xc
    v_add_f32_dpp v17, v50, v51 row_ror:8 row_mask:0xf bank_mask:0xc
    v_add_f32_dpp v18, v52, v53 row_ror:8 row_mask:0xf bank_mask:0xc
    v_add_f32_dpp v19, v54, v55 row_ror:8 row_mask:0xf bank_mask:0xc
    v_add_f32_dpp v20, v56, v57 row_ror:8 row_mask:0xf bank_mask:0xc
    v_add_f32_dpp v21, v58, v59 row_ror:8 row_mask:0xf bank_mask:0xc
    v_add_f32_dpp v22, v60, v61 row_ror:8 row_mask:0xf bank_mask:0xc
    v_add_f32_dpp v23, v62, v63 row_ror:8 row_mask:0xf bank_mask:0xc
    v_max_f32 v14, v16, v17
    v_max3_f32 v14, v14, v18, v19
    v_max3_f32 v14, v14, v20, v21
    v_max3_f32 v14, v14, v22, v23
    s_waitcnt vmcnt(5)
    s_xor_b32 s53, s42, 133120
    buffer_load_dwordx4 v[232:235], v1, s[16:19], s53 offen nt
    v_mfma_f32_16x16x32_bf16 v[32:35], v[128:131], v[192:195], 0
    v_mfma_f32_16x16x32_bf16 v[36:39], v[136:139], v[192:195], 0
    v_mfma_f32_16x16x32_bf16 v[40:43], v[144:147], v[192:195], 0
    v_mfma_f32_16x16x32_bf16 v[44:47], v[152:155], v[192:195], 0
    v_mfma_f32_16x16x32_bf16 v[32:35], v[132:135], v[196:199], v[32:35]
    v_mfma_f32_16x16x32_bf16 v[36:39], v[140:143], v[196:199], v[36:39]
    v_mfma_f32_16x16x32_bf16 v[40:43], v[148:151], v[196:199], v[40:43]
    v_mfma_f32_16x16x32_bf16 v[44:47], v[156:159], v[196:199], v[44:47]
    s_waitcnt vmcnt(5)
    s_xor_b32 s53, s42, 134144
    buffer_load_dwordx4 v[236:239], v1, s[16:19], s53 offen nt
    v_mfma_f32_16x16x32_bf16 v[48:51], v[160:163], v[192:195], 0
    v_mfma_f32_16x16x32_bf16 v[52:55], v[168:171], v[192:195], 0
    v_mfma_f32_16x16x32_bf16 v[56:59], v[176:179], v[192:195], 0
    v_mfma_f32_16x16x32_bf16 v[60:63], v[184:187], v[192:195], 0
    v_mfma_f32_16x16x32_bf16 v[48:51], v[164:167], v[196:199], v[48:51]
    v_mfma_f32_16x16x32_bf16 v[52:55], v[172:175], v[196:199], v[52:55]
    v_mfma_f32_16x16x32_bf16 v[56:59], v[180:183], v[196:199], v[56:59]
    v_mfma_f32_16x16x32_bf16 v[60:63], v[188:191], v[196:199], v[60:63]
    s_waitcnt vmcnt(5)
    s_xor_b32 s53, s42, 262144
    buffer_load_dwordx4 v[240:243], v1, s[16:19], s53 offen nt
    v_add_f32_dpp v24, v33, v32 row_ror:8 row_mask:0xf bank_mask:0x3
    v_add_f32_dpp v25, v35, v34 row_ror:8 row_mask:0xf bank_mask:0x3
    v_add_f32_dpp v26, v37, v36 row_ror:8 row_mask:0xf bank_mask:0x3
    v_add_f32_dpp v27, v39, v38 row_ror:8 row_mask:0xf bank_mask:0x3
    v_add_f32_dpp v28, v41, v40 row_ror:8 row_mask:0xf bank_mask:0x3
    v_add_f32_dpp v29, v43, v42 row_ror:8 row_mask:0xf bank_mask:0x3
    v_add_f32_dpp v30, v45, v44 row_ror:8 row_mask:0xf bank_mask:0x3
    v_add_f32_dpp v31, v47, v46 row_ror:8 row_mask:0xf bank_mask:0x3
    v_add_f32_dpp v24, v48, v49 row_ror:8 row_mask:0xf bank_mask:0xc
    v_add_f32_dpp v25, v50, v51 row_ror:8 row_mask:0xf bank_mask:0xc
    v_add_f32_dpp v26, v52, v53 row_ror:8 row_mask:0xf bank_mask:0xc
    v_add_f32_dpp v27, v54, v55 row_ror:8 row_mask:0xf bank_mask:0xc
    v_add_f32_dpp v28, v56, v57 row_ror:8 row_mask:0xf bank_mask:0xc
    v_add_f32_dpp v29, v58, v59 row_ror:8 row_mask:0xf bank_mask:0xc
    v_add_f32_dpp v30, v60, v61 row_ror:8 row_mask:0xf bank_mask:0xc
    v_add_f32_dpp v31, v62, v63 row_ror:8 row_mask:0xf bank_mask:0xc
    v_max3_f32 v14, v14, v24, v25
    v_max3_f32 v14, v14, v26, v27
    v_max3_f32 v14, v14, v28, v29
    v_max3_f32 v14, v14, v30, v31
    s_waitcnt vmcnt(5)
    s_xor_b32 s53, s42, 263168
    buffer_load_dwordx4 v[244:247], v1, s[16:19], s53 offen nt
    v_max_f32_dpp v14, v14, v14 row_ror:8 row_mask:0xf bank_mask:0xf
    v_mov_b32 v13, v14
    s_nop 1
    v_permlane16_swap_b32 v14, v13
    v_max_f32 v14, v14, v13
    v_mov_b32 v13, v14
    s_nop 1
    v_permlane32_swap_b32 v14, v13
    v_max_f32 v14, v14, v13
    v_sub_f32 v16, v16, v14
    v_sub_f32 v17, v17, v14
    v_sub_f32 v18, v18, v14
    v_sub_f32 v19, v19, v14
    v_sub_f32 v20, v20, v14
    v_sub_f32 v21, v21, v14
    v_sub_f32 v22, v22, v14
    v_sub_f32 v23, v23, v14
    v_sub_f32 v24, v24, v14
    v_sub_f32 v25, v25, v14
    v_sub_f32 v26, v26, v14
    v_sub_f32 v27, v27, v14
    v_sub_f32 v28, v28, v14
    v_sub_f32 v29, v29, v14
    v_sub_f32 v30, v30, v14
    v_sub_f32 v31, v31, v14
    v_exp_f32 v16, v16
    v_exp_f32 v17, v17
    v_exp_f32 v18, v18
    v_exp_f32 v19, v19
    v_exp_f32 v20, v20
    v_exp_f32 v21, v21
    v_exp_f32 v22, v22
    v_exp_f32 v23, v23
    v_exp_f32 v24, v24
    v_exp_f32 v25, v25
    v_exp_f32 v26, v26
    v_exp_f32 v27, v27
    v_exp_f32 v28, v28
    v_exp_f32 v29, v29
    v_exp_f32 v30, v30
    v_exp_f32 v31, v31
    s_waitcnt vmcnt(5)
    s_xor_b32 s53, s42, 264192
    buffer_load_dwordx4 v[248:251], v1, s[16:19], s53 offen nt
    v_cvt_pk_bf16_f32 v200, v16, v17
    v_cvt_pk_bf16_f32 v201, v18, v19
    v_cvt_pk_bf16_f32 v202, v20, v21
    v_cvt_pk_bf16_f32 v203, v22, v23
    v_cvt_pk_bf16_f32 v204, v24, v25
    v_cvt_pk_bf16_f32 v205, v26, v27
    v_cvt_pk_bf16_f32 v206, v28, v29
    v_cvt_pk_bf16_f32 v207, v30, v31
    v_add_f32 v16, v16, v24
    v_add_f32 v17, v17, v25
    v_add_f32 v18, v18, v26
    v_add_f32 v19, v19, v27
    v_add_f32 v20, v20, v28
    v_add_f32 v21, v21, v29
    v_add_f32 v22, v22, v30
    v_add_f32 v23, v23, v31
    v_add_f32 v16, v16, v20
    v_add_f32 v17, v17, v21
    v_add_f32 v18, v18, v22
    v_add_f32 v19, v19, v23
    v_add_f32 v16, v16, v18
    v_add_f32 v17, v17, v19
    v_add_f32 v15, v16, v17
    s_nop 1
    v_add_f32_dpp v15, v15, v15 row_ror:8 row_mask:0xf bank_mask:0xf
    v_mov_b32 v13, v15
    s_nop 1
    v_permlane16_swap_b32 v15, v13
    v_add_f32 v15, v15, v13
    v_mov_b32 v13, v15
    s_nop 1
    v_permlane32_swap_b32 v15, v13
    v_add_f32 v15, v15, v13
    ds_write_b64 v10, v[14:15]
    v_max_u32 v0, 3, v0
    ds_write_b32 v12, v0
    s_waitcnt vmcnt(5)
    s_xor_b32 s53, s42, 265216
    buffer_load_dwordx4 v[252:255], v1, s[16:19], s53 offen nt
    v_cndmask_b32 v48, 0, v200, s[62:63]
    v_mov_b32_dpp v50, v200 row_shr:8 row_mask:0xf bank_mask:0xf bound_ctrl:0
    v_cndmask_b32 v49, 0, v201, s[62:63]
    v_mov_b32_dpp v51, v201 row_shr:8 row_mask:0xf bank_mask:0xf bound_ctrl:0
    v_perm_b32 v64, v212, v208, s54
    v_perm_b32 v66, v214, v210, s54
    v_perm_b32 v68, v212, v208, s55
    v_perm_b32 v70, v214, v210, s55
    v_perm_b32 v72, v213, v209, s54
    v_perm_b32 v74, v215, v211, s54
    v_perm_b32 v76, v213, v209, s55
    v_perm_b32 v78, v215, v211, s55
    s_waitcnt vmcnt(5)
    s_xor_b32 s53, s42, 393216
    buffer_load_dwordx4 v[208:211], v1, s[16:19], s53 offen nt
    v_perm_b32 v65, v220, v216, s54
    v_perm_b32 v67, v222, v218, s54
    v_perm_b32 v69, v220, v216, s55
    v_perm_b32 v71, v222, v218, s55
    v_perm_b32 v73, v221, v217, s54
    v_perm_b32 v75, v223, v219, s54
    v_perm_b32 v77, v221, v217, s55
    v_perm_b32 v79, v223, v219, s55
    v_mfma_f32_16x16x32_bf16 v[32:35], v[64:67], v[48:51], 0
    v_mfma_f32_16x16x32_bf16 v[36:39], v[68:71], v[48:51], 0
    v_mfma_f32_16x16x32_bf16 v[40:43], v[72:75], v[48:51], 0
    v_mfma_f32_16x16x32_bf16 v[44:47], v[76:79], v[48:51], 0
    s_waitcnt vmcnt(5)
    s_xor_b32 s53, s42, 394240
    buffer_load_dwordx4 v[212:215], v1, s[16:19], s53 offen nt
    v_cndmask_b32 v52, 0, v202, s[62:63]
    v_mov_b32_dpp v54, v202 row_shr:8 row_mask:0xf bank_mask:0xf bound_ctrl:0
    v_cndmask_b32 v53, 0, v203, s[62:63]
    v_mov_b32_dpp v55, v203 row_shr:8 row_mask:0xf bank_mask:0xf bound_ctrl:0
    v_perm_b32 v80, v228, v224, s54
    v_perm_b32 v82, v230, v226, s54
    v_perm_b32 v84, v228, v224, s55
    v_perm_b32 v86, v230, v226, s55
    v_perm_b32 v88, v229, v225, s54
    v_perm_b32 v90, v231, v227, s54
    v_perm_b32 v92, v229, v225, s55
    v_perm_b32 v94, v231, v227, s55
    s_waitcnt vmcnt(5)
    s_xor_b32 s53, s42, 395264
    buffer_load_dwordx4 v[216:219], v1, s[16:19], s53 offen nt
    v_perm_b32 v81, v236, v232, s54
    v_perm_b32 v83, v238, v234, s54
    v_perm_b32 v85, v236, v232, s55
    v_perm_b32 v87, v238, v234, s55
    v_perm_b32 v89, v237, v233, s54
    v_perm_b32 v91, v239, v235, s54
    v_perm_b32 v93, v237, v233, s55
    v_perm_b32 v95, v239, v235, s55
    v_mfma_f32_16x16x32_bf16 v[32:35], v[80:83], v[52:55], v[32:35]
    v_mfma_f32_16x16x32_bf16 v[36:39], v[84:87], v[52:55], v[36:39]
    v_mfma_f32_16x16x32_bf16 v[40:43], v[88:91], v[52:55], v[40:43]
    v_mfma_f32_16x16x32_bf16 v[44:47], v[92:95], v[52:55], v[44:47]
    s_waitcnt vmcnt(5)
    s_xor_b32 s53, s42, 396288
    buffer_load_dwordx4 v[220:223], v1, s[16:19], s53 offen nt
    v_mov_b32_dpp v56, v200 row_shl:8 row_mask:0xf bank_mask:0xf bound_ctrl:0
    v_cndmask_b32 v58, v200, 0, s[62:63]
    v_mov_b32_dpp v57, v201 row_shl:8 row_mask:0xf bank_mask:0xf bound_ctrl:0
    v_cndmask_b32 v59, v201, 0, s[62:63]
    v_perm_b32 v96, v244, v240, s54
    v_perm_b32 v98, v246, v242, s54
    v_perm_b32 v100, v244, v240, s55
    v_perm_b32 v102, v246, v242, s55
    v_perm_b32 v104, v245, v241, s54
    v_perm_b32 v106, v247, v243, s54
    v_perm_b32 v108, v245, v241, s55
    v_perm_b32 v110, v247, v243, s55
    s_waitcnt vmcnt(5)
    s_xor_b32 s53, s57, 524288
    buffer_load_dwordx4 v[224:227], v1, s[16:19], s53 offen nt
    s_waitcnt vmcnt(5)
    s_xor_b32 s53, s57, 525312
    buffer_load_dwordx4 v[228:231], v1, s[16:19], s53 offen nt
    v_perm_b32 v97, v252, v248, s54
    v_perm_b32 v99, v254, v250, s54
    v_perm_b32 v101, v252, v248, s55
    v_perm_b32 v103, v254, v250, s55
    v_perm_b32 v105, v253, v249, s54
    v_perm_b32 v107, v255, v251, s54
    v_perm_b32 v109, v253, v249, s55
    v_perm_b32 v111, v255, v251, s55
    v_mfma_f32_16x16x32_bf16 v[32:35], v[96:99], v[56:59], v[32:35]
    v_mfma_f32_16x16x32_bf16 v[36:39], v[100:103], v[56:59], v[36:39]
    v_mfma_f32_16x16x32_bf16 v[40:43], v[104:107], v[56:59], v[40:43]
    v_mfma_f32_16x16x32_bf16 v[44:47], v[108:111], v[56:59], v[44:47]
    s_waitcnt vmcnt(5)
    s_xor_b32 s53, s57, 526336
    buffer_load_dwordx4 v[232:235], v1, s[16:19], s53 offen nt
    s_waitcnt vmcnt(5)
    s_xor_b32 s53, s57, 527360
    buffer_load_dwordx4 v[236:239], v1, s[16:19], s53 offen nt
    v_mov_b32_dpp v60, v202 row_shl:8 row_mask:0xf bank_mask:0xf bound_ctrl:0
    v_cndmask_b32 v62, v202, 0, s[62:63]
    v_mov_b32_dpp v61, v203 row_shl:8 row_mask:0xf bank_mask:0xf bound_ctrl:0
    v_cndmask_b32 v63, v203, 0, s[62:63]
    v_perm_b32 v112, v212, v208, s54
    v_perm_b32 v114, v214, v210, s54
    v_perm_b32 v116, v212, v208, s55
    v_perm_b32 v118, v214, v210, s55
    v_perm_b32 v120, v213, v209, s54
    v_perm_b32 v122, v215, v211, s54
    v_perm_b32 v124, v213, v209, s55
    v_perm_b32 v126, v215, v211, s55
    s_waitcnt vmcnt(5)
    s_xor_b32 s53, s57, 655360
    buffer_load_dwordx4 v[240:243], v1, s[16:19], s53 offen nt
    s_waitcnt vmcnt(5)
    s_xor_b32 s53, s57, 656384
    buffer_load_dwordx4 v[244:247], v1, s[16:19], s53 offen nt
    v_perm_b32 v113, v220, v216, s54
    v_perm_b32 v115, v222, v218, s54
    v_perm_b32 v117, v220, v216, s55
    v_perm_b32 v119, v222, v218, s55
    v_perm_b32 v121, v221, v217, s54
    v_perm_b32 v123, v223, v219, s54
    v_perm_b32 v125, v221, v217, s55
    v_perm_b32 v127, v223, v219, s55
    v_mfma_f32_16x16x32_bf16 v[32:35], v[112:115], v[60:63], v[32:35]
    v_mfma_f32_16x16x32_bf16 v[36:39], v[116:119], v[60:63], v[36:39]
    v_mfma_f32_16x16x32_bf16 v[40:43], v[120:123], v[60:63], v[40:43]
    v_mfma_f32_16x16x32_bf16 v[44:47], v[124:127], v[60:63], v[44:47]
    s_waitcnt vmcnt(5)
    s_xor_b32 s53, s57, 657408
    buffer_load_dwordx4 v[248:251], v1, s[16:19], s53 offen nt
    s_waitcnt vmcnt(5)
    s_xor_b32 s53, s57, 658432
    buffer_load_dwordx4 v[252:255], v1, s[16:19], s53 offen nt
    v_cndmask_b32 v48, 0, v204, s[62:63]
    v_mov_b32_dpp v50, v204 row_shr:8 row_mask:0xf bank_mask:0xf bound_ctrl:0
    v_cndmask_b32 v49, 0, v205, s[62:63]
    v_mov_b32_dpp v51, v205 row_shr:8 row_mask:0xf bank_mask:0xf bound_ctrl:0
    v_perm_b32 v128, v228, v224, s54
    v_perm_b32 v130, v230, v226, s54
    v_perm_b32 v132, v228, v224, s55
    v_perm_b32 v134, v230, v226, s55
    v_perm_b32 v136, v229, v225, s54
    v_perm_b32 v138, v231, v227, s54
    v_perm_b32 v140, v229, v225, s55
    v_perm_b32 v142, v231, v227, s55
    s_waitcnt vmcnt(5)
    s_xor_b32 s53, s57, 786432
    buffer_load_dwordx4 v[208:211], v1, s[16:19], s53 offen nt
    s_waitcnt vmcnt(5)
    s_xor_b32 s53, s57, 787456
    buffer_load_dwordx4 v[212:215], v1, s[16:19], s53 offen nt
    v_max_u32 v0, 4, v0
    ds_write_b32 v12, v0
    v_perm_b32 v129, v236, v232, s54
    v_perm_b32 v131, v238, v234, s54
    v_perm_b32 v133, v236, v232, s55
    v_perm_b32 v135, v238, v234, s55
    v_perm_b32 v137, v237, v233, s54
    v_perm_b32 v139, v239, v235, s54
    v_perm_b32 v141, v237, v233, s55
    v_perm_b32 v143, v239, v235, s55
    v_mfma_f32_16x16x32_bf16 v[32:35], v[128:131], v[48:51], v[32:35]
    v_mfma_f32_16x16x32_bf16 v[36:39], v[132:135], v[48:51], v[36:39]
    v_mfma_f32_16x16x32_bf16 v[40:43], v[136:139], v[48:51], v[40:43]
    v_mfma_f32_16x16x32_bf16 v[44:47], v[140:143], v[48:51], v[44:47]
    s_waitcnt vmcnt(5)
    s_xor_b32 s53, s57, 788480
    buffer_load_dwordx4 v[216:219], v1, s[16:19], s53 offen nt
    v_max_u32 v0, 5, v0
    ds_write_b32 v12, v0
    s_waitcnt vmcnt(5)
    s_xor_b32 s53, s57, 789504
    buffer_load_dwordx4 v[220:223], v1, s[16:19], s53 offen nt
    v_cndmask_b32 v52, 0, v206, s[62:63]
    v_mov_b32_dpp v54, v206 row_shr:8 row_mask:0xf bank_mask:0xf bound_ctrl:0
    v_cndmask_b32 v53, 0, v207, s[62:63]
    v_mov_b32_dpp v55, v207 row_shr:8 row_mask:0xf bank_mask:0xf bound_ctrl:0
    v_perm_b32 v144, v244, v240, s54
    v_perm_b32 v146, v246, v242, s54
    v_perm_b32 v148, v244, v240, s55
    v_perm_b32 v150, v246, v242, s55
    v_perm_b32 v152, v245, v241, s54
    v_perm_b32 v154, v247, v243, s54
    v_perm_b32 v156, v245, v241, s55
    v_perm_b32 v158, v247, v243, s55
    s_waitcnt vmcnt(5)
    s_xor_b32 s53, s57, 917504
    buffer_load_dwordx4 v[224:227], v1, s[16:19], s53 offen nt
    s_waitcnt vmcnt(5)
    s_xor_b32 s53, s57, 918528
    buffer_load_dwordx4 v[228:231], v1, s[16:19], s53 offen nt
    v_perm_b32 v145, v252, v248, s54
    v_perm_b32 v147, v254, v250, s54
    v_perm_b32 v149, v252, v248, s55
    v_perm_b32 v151, v254, v250, s55
    v_perm_b32 v153, v253, v249, s54
    v_perm_b32 v155, v255, v251, s54
    v_perm_b32 v157, v253, v249, s55
    v_perm_b32 v159, v255, v251, s55
    v_mfma_f32_16x16x32_bf16 v[32:35], v[144:147], v[52:55], v[32:35]
    v_mfma_f32_16x16x32_bf16 v[36:39], v[148:151], v[52:55], v[36:39]
    v_mfma_f32_16x16x32_bf16 v[40:43], v[152:155], v[52:55], v[40:43]
    v_mfma_f32_16x16x32_bf16 v[44:47], v[156:159], v[52:55], v[44:47]
    s_waitcnt vmcnt(5)
    s_xor_b32 s53, s57, 919552
    buffer_load_dwordx4 v[232:235], v1, s[16:19], s53 offen nt
    s_waitcnt vmcnt(5)
    s_xor_b32 s53, s57, 920576
    buffer_load_dwordx4 v[236:239], v1, s[16:19], s53 offen nt
    v_mov_b32_dpp v56, v204 row_shl:8 row_mask:0xf bank_mask:0xf bound_ctrl:0
    v_cndmask_b32 v58, v204, 0, s[62:63]
    v_mov_b32_dpp v57, v205 row_shl:8 row_mask:0xf bank_mask:0xf bound_ctrl:0
    v_cndmask_b32 v59, v205, 0, s[62:63]
    v_perm_b32 v160, v212, v208, s54
    v_perm_b32 v162, v214, v210, s54
    v_perm_b32 v164, v212, v208, s55
    v_perm_b32 v166, v214, v210, s55
    v_perm_b32 v168, v213, v209, s54
    v_perm_b32 v170, v215, v211, s54
    v_perm_b32 v172, v213, v209, s55
    v_perm_b32 v174, v215, v211, s55
    s_waitcnt vmcnt(5)
    s_waitcnt vmcnt(4)
    v_perm_b32 v161, v220, v216, s54
    v_perm_b32 v163, v222, v218, s54
    v_perm_b32 v165, v220, v216, s55
    v_perm_b32 v167, v222, v218, s55
    v_perm_b32 v169, v221, v217, s54
    v_perm_b32 v171, v223, v219, s54
    v_perm_b32 v173, v221, v217, s55
    v_perm_b32 v175, v223, v219, s55
    v_mfma_f32_16x16x32_bf16 v[32:35], v[160:163], v[56:59], v[32:35]
    v_mfma_f32_16x16x32_bf16 v[36:39], v[164:167], v[56:59], v[36:39]
    v_mfma_f32_16x16x32_bf16 v[40:43], v[168:171], v[56:59], v[40:43]
    v_mfma_f32_16x16x32_bf16 v[44:47], v[172:175], v[56:59], v[44:47]

L_tw_3:
    ds_read_b32 v13, v11 offset:32
    s_sub_u32 s74, s74, 1
    s_cmp_lt_i32 s74, 0
    s_waitcnt lgkmcnt(0)
    v_readfirstlane_b32 s61, v13
    s_cbranch_scc1 L_tk_4
    s_cmp_eq_u32 s61, 0
    s_cbranch_scc1 L_tw_3
L_tk_4:
    s_and_b32 s60, s61, 127
    v_lshl_add_u32 v4, s60, 7, v4

    s_cmp_ge_u32 s60, 56
    s_cbranch_scc1 L_skip
    s_waitcnt vmcnt(3)
    s_add_u32 m0, s64, 32768
    s_mov_b32 s53, 0
    buffer_load_dwordx4 v4, s[24:27], s53 offen nt lds
    s_waitcnt vmcnt(3)
    s_add_u32 m0, s64, 36864
    s_mov_b32 s53, 229376
    buffer_load_dwordx4 v4, s[24:27], s53 offen nt lds
    s_add_u32 m0, s64, 40960
    s_mov_b32 s53, 458752
    buffer_load_dwordx4 v4, s[24:27], s53 offen nt lds
    s_add_u32 m0, s64, 45056
    s_mov_b32 s53, 688128
    buffer_load_dwordx4 v4, s[24:27], s53 offen nt lds
    v_mov_b32_dpp v60, v206 row_shl:8 row_mask:0xf bank_mask:0xf bound_ctrl:0
    v_cndmask_b32 v62, v206, 0, s[62:63]
    v_mov_b32_dpp v61, v207 row_shl:8 row_mask:0xf bank_mask:0xf bound_ctrl:0
    v_cndmask_b32 v63, v207, 0, s[62:63]
    v_perm_b32 v176, v228, v224, s54
    v_perm_b32 v178, v230, v226, s54
    v_perm_b32 v180, v228, v224, s55
    v_perm_b32 v182, v230, v226, s55
    v_perm_b32 v184, v229, v225, s54
    v_perm_b32 v186, v231, v227, s54
    v_perm_b32 v188, v229, v225, s55
    v_perm_b32 v190, v231, v227, s55
    s_waitcnt vmcnt(5)
    s_add_u32 m0, s64, 49152
    s_mov_b32 s53, 917504
    buffer_load_dwordx4 v4, s[24:27], s53 offen nt lds
    s_waitcnt vmcnt(5)
    s_add_u32 m0, s64, 53248
    s_mov_b32 s53, 1146880
    buffer_load_dwordx4 v4, s[24:27], s53 offen nt lds
    v_perm_b32 v177, v236, v232, s54
    v_perm_b32 v179, v238, v234, s54
    v_perm_b32 v181, v236, v232, s55
    v_perm_b32 v183, v238, v234, s55
    v_perm_b32 v185, v237, v233, s54
    v_perm_b32 v187, v239, v235, s54
    v_perm_b32 v189, v237, v233, s55
    v_perm_b32 v191, v239, v235, s55
    v_mfma_f32_16x16x32_bf16 v[32:35], v[176:179], v[60:63], v[32:35]
    v_mfma_f32_16x16x32_bf16 v[36:39], v[180:183], v[60:63], v[36:39]
    v_mfma_f32_16x16x32_bf16 v[40:43], v[184:187], v[60:63], v[40:43]
    v_mfma_f32_16x16x32_bf16 v[44:47], v[188:191], v[60:63], v[44:47]
    s_nop 4
    ds_write_b128 v9, v[32:35] offset:0
    ds_write_b128 v9, v[36:39] offset:16
    ds_write_b128 v9, v[40:43] offset:32
    ds_write_b128 v9, v[44:47] offset:48
    v_max_u32 v0, 6, v0
    ds_write_b32 v12, v0
    s_waitcnt vmcnt(5)
    s_add_u32 m0, s64, 57344
    s_mov_b32 s53, 1376256
    buffer_load_dwordx4 v4, s[24:27], s53 offen nt lds
    s_waitcnt vmcnt(5)
    s_add_u32 m0, s64, 61440
    s_mov_b32 s53, 1605632
    buffer_load_dwordx4 v4, s[24:27], s53 offen nt lds
    s_mov_b32 s68, 0x44444444
    s_mov_b32 s69, 0x44665555
    s_lshr_b32 s70, s61, 8
    s_and_b32 s70, s70, 60
    s_lshr_b64 s[68:69], s[68:69], s70
    s_and_b32 s71, s68, 15
    v_max_u32 v0, 7, v0
    ds_write_b32 v12, v0
    s_waitcnt vmcnt(5)
    s_cmp_gt_u32 s71, 5
    s_cbranch_scc1 L_go_5
    s_waitcnt vmcnt(4)
    v_max_u32 v0, 8, v0
    ds_write_b32 v12, v0
    s_cmp_gt_u32 s71, 4
    s_cbranch_scc1 L_go_5
    s_waitcnt vmcnt(3)
    v_max_u32 v0, 9, v0
    ds_write_b32 v12, v0
L_go_5:
    s_add_u32 m0, s65, 65536
    s_mov_b32 s53, 0
    buffer_load_dwordx4 v5, s[32:35], s53 offen nt lds
    s_waitcnt vmcnt(5)
    s_cmp_gt_u32 s71, 5
    s_cbranch_scc1 L_go_6
    s_waitcnt vmcnt(4)
    v_max_u32 v0, 9, v0
    ds_write_b32 v12, v0
    s_cmp_gt_u32 s71, 4
    s_cbranch_scc1 L_go_6
    s_waitcnt vmcnt(3)
    v_max_u32 v0, 10, v0
    ds_write_b32 v12, v0
L_go_6:
    s_add_u32 m0, s65, 66560
    s_mov_b32 s53, 8192
    buffer_load_dwordx4 v5, s[32:35], s53 offen nt lds
    v_max_u32 v0, 8, v0
    ds_write_b32 v12, v0
    s_waitcnt vmcnt(5)
    s_cmp_gt_u32 s71, 5
    s_cbranch_scc1 L_go_7
    s_waitcnt vmcnt(4)
    v_max_u32 v0, 10, v0
    ds_write_b32 v12, v0
    s_cmp_gt_u32 s71, 4
    s_cbranch_scc1 L_go_7
    s_waitcnt vmcnt(3)
L_go_7:
    s_add_u32 m0, s65, 98304
    s_mov_b32 s53, 0
    buffer_load_dwordx4 v6, s[28:31], s53 offen nt lds
    v_max_u32 v0, 9, v0
    ds_write_b32 v12, v0
    s_waitcnt vmcnt(5)
    s_cmp_gt_u32 s71, 5
    s_cbranch_scc1 L_go_8
    s_waitcnt vmcnt(4)
    s_cmp_gt_u32 s71, 4
    s_cbranch_scc1 L_go_8
    s_waitcnt vmcnt(3)
    v_max_u32 v0, 11, v0
    ds_write_b32 v12, v0
L_go_8:
    s_add_u32 m0, s65, 73728
    s_mov_b32 s53, 65536
    buffer_load_dwordx4 v5, s[32:35], s53 offen nt lds
    v_max_u32 v0, 10, v0
    ds_write_b32 v12, v0
    s_waitcnt vmcnt(5)
    s_cmp_gt_u32 s71, 5
    s_cbranch_scc1 L_go_9
    s_waitcnt vmcnt(4)
    v_max_u32 v0, 11, v0
    ds_write_b32 v12, v0
    s_cmp_gt_u32 s71, 4
    s_cbranch_scc1 L_go_9
    s_waitcnt vmcnt(3)
L_go_9:
    s_add_u32 m0, s65, 99328
    s_mov_b32 s53, 8192
    buffer_load_dwordx4 v6, s[28:31], s53 offen nt lds
    s_waitcnt vmcnt(5)
    s_cmp_gt_u32 s71, 5
    s_cbranch_scc1 L_go_10
    s_waitcnt vmcnt(4)
    s_cmp_gt_u32 s71, 4
    s_cbranch_scc1 L_go_10
    s_waitcnt vmcnt(3)
L_go_10:
    s_add_u32 m0, s65, 74752
    s_mov_b32 s53, 73728
    buffer_load_dwordx4 v5, s[32:35], s53 offen nt lds
    v_max_u32 v0, 11, v0
    ds_write_b32 v12, v0
    s_waitcnt vmcnt(5)
    s_cmp_gt_u32 s71, 5
    s_cbranch_scc1 L_go_11
    s_waitcnt vmcnt(4)
    s_cmp_gt_u32 s71, 4
    s_cbranch_scc1 L_go_11
    s_waitcnt vmcnt(3)
L_go_11:
    s_add_u32 m0, s65, 106496
    s_mov_b32 s53, 65536
    buffer_load_dwordx4 v6, s[28:31], s53 offen nt lds
    s_waitcnt vmcnt(5)
    s_cmp_gt_u32 s71, 5
    s_cbranch_scc1 L_go_12
    s_waitcnt vmcnt(4)
    s_cmp_gt_u32 s71, 4
    s_cbranch_scc1 L_go_12
    s_waitcnt vmcnt(3)
L_go_12:
    s_add_u32 m0, s65, 81920
    s_mov_b32 s53, 131072
    buffer_load_dwordx4 v5, s[32:35], s53 offen nt lds
    s_waitcnt vmcnt(5)
    s_cmp_gt_u32 s71, 5
    s_cbranch_scc1 L_go_13
    s_waitcnt vmcnt(4)
    s_cmp_gt_u32 s71, 4
    s_cbranch_scc1 L_go_13
    s_waitcnt vmcnt(3)
L_go_13:
    s_add_u32 m0, s65, 107520
    s_mov_b32 s53, 73728
    buffer_load_dwordx4 v6, s[28:31], s53 offen nt lds
    s_waitcnt vmcnt(5)
    s_cmp_gt_u32 s71, 5
    s_cbranch_scc1 L_go_14
    s_waitcnt vmcnt(4)
    s_cmp_gt_u32 s71, 4
    s_cbranch_scc1 L_go_14
    s_waitcnt vmcnt(3)
L_go_14:
    s_add_u32 m0, s65, 82944
    s_mov_b32 s53, 139264
    buffer_load_dwordx4 v5, s[32:35], s53 offen nt lds
    s_waitcnt vmcnt(5)
    s_cmp_gt_u32 s71, 5
    s_cbranch_scc1 L_go_15
    s_waitcnt vmcnt(4)
    s_cmp_gt_u32 s71, 4
    s_cbranch_scc1 L_go_15
    s_waitcnt vmcnt(3)
L_go_15:
    s_add_u32 m0, s65, 114688
    s_mov_b32 s53, 131072
    buffer_load_dwordx4 v6, s[28:31], s53 offen nt lds
    s_waitcnt vmcnt(5)
    s_cmp_gt_u32 s71, 5
    s_cbranch_scc1 L_go_16
    s_waitcnt vmcnt(4)
    s_cmp_gt_u32 s71, 4
    s_cbranch_scc1 L_go_16
    s_waitcnt vmcnt(3)
L_go_16:
    s_add_u32 m0, s65, 90112
    s_mov_b32 s53, 196608
    buffer_load_dwordx4 v5, s[32:35], s53 offen nt lds
    s_waitcnt vmcnt(5)
    s_cmp_gt_u32 s71, 5
    s_cbranch_scc1 L_go_17
    s_waitcnt vmcnt(4)
    s_cmp_gt_u32 s71, 4
    s_cbranch_scc1 L_go_17
    s_waitcnt vmcnt(3)
L_go_17:
    s_add_u32 m0, s65, 115712
    s_mov_b32 s53, 139264
    buffer_load_dwordx4 v6, s[28:31], s53 offen nt lds
    s_waitcnt vmcnt(5)
    s_cmp_gt_u32 s71, 5
    s_cbranch_scc1 L_go_18
    s_waitcnt vmcnt(4)
    s_cmp_gt_u32 s71, 4
    s_cbranch_scc1 L_go_18
    s_waitcnt vmcnt(3)
L_go_18:
    s_add_u32 m0, s65, 91136
    s_mov_b32 s53, 204800
    buffer_load_dwordx4 v5, s[32:35], s53 offen nt lds
    v_add_u32 v76, s64, v1
    s_mov_b32 s38, 3145728
    s_mov_b32 s39, 0x20000
    s_mov_b32 s44, 0x10000000
    ds_read_b32 v77, v11 offset:16
    ds_read_b128 v[64:67], v76 offset:17408
    ds_read_b128 v[68:71], v76 offset:21504
    ds_read_b128 v[72:75], v76 offset:25600
    s_waitcnt vmcnt(5)
    s_cmp_gt_u32 s71, 5
    s_cbranch_scc1 L_go_19
    s_waitcnt vmcnt(4)
    s_cmp_gt_u32 s71, 4
    s_cbranch_scc1 L_go_19
    s_waitcnt vmcnt(3)
L_go_19:
    s_add_u32 m0, s66, 122880
    s_mov_b32 s53, s56
    buffer_load_dwordx4 v7, s[28:31], s53 offen nt lds
    s_waitcnt vmcnt(3)
    v_max_u32 v0, 12, v0
    ds_write_b32 v12, v0

L_gs_20:
    s_waitcnt lgkmcnt(0)
    v_cmp_gt_u32 vcc, 3, v77
    v_readfirstlane_b32 s42, v73
    v_readfirstlane_b32 s43, v74
    s_cbranch_vccnz L_gr_22
L_gk_21:

    s_mov_b32 s53, 0
    buffer_load_dwordx4 v[80:83], v64, s[36:39], s53 offen sc1
    s_mov_b32 s53, 114688
    buffer_load_dwordx4 v[84:87], v64, s[36:39], s53 offen sc1
    s_mov_b32 vcc_lo, 0xffff0000
    s_mov_b32 vcc_hi, vcc_lo
    v_cndmask_b32 v72, 0, v68, vcc
    v_cndmask_b32 v73, 0, v69, vcc
    v_cndmask_b32 v74, 0, v70, vcc
    v_cndmask_b32 v75, 0, v71, vcc
    v_cndmask_b32 v68, v68, 0, vcc
    v_cndmask_b32 v69, v69, 0, vcc
    v_cndmask_b32 v70, v70, 0, vcc
    v_cndmask_b32 v71, v71, 0, vcc
    s_waitcnt vmcnt(4)
    v_max_u32 v0, 13, v0
    ds_write_b32 v12, v0
    s_waitcnt vmcnt(3)
    v_max_u32 v0, 14, v0
    ds_write_b32 v12, v0
    s_waitcnt vmcnt(2)
    v_max_u32 v0, 15, v0
    ds_write_b32 v12, v0
    s_waitcnt vmcnt(1)

    v_alignbit_b32 v88, v81, s44, 2
    v_lshl_add_u64 v[82:83], v[82:83], 0, v[66:67]
    v_alignbit_b32 v88, v80, v88, 3
    v_lshl_add_u64 v[80:81], v[80:81], 0, s[42:43]
    v_and_b32 v80, -4, v80
    v_and_b32 v81, -4, v81

    v_or3_b32 v13, v80, v81, v82
    v_or_b32 v13, v13, v83
    v_fma_mix_f32 v96, v80, |v88|, v68 op_sel:[0,0,0] op_sel_hi:[1,0,0]
    v_fma_mix_f32 v97, v80, |v88|, v69 op_sel:[1,0,0] op_sel_hi:[1,0,0]
    v_fma_mix_f32 v98, v81, |v88|, v70 op_sel:[0,0,0] op_sel_hi:[1,0,0]
    v_fma_mix_f32 v99, v81, |v88|, v71 op_sel:[1,0,0] op_sel_hi:[1,0,0]
    v_fma_mix_f32 v100, v82, |v88|, v72 op_sel:[0,0,0] op_sel_hi:[1,0,0]
    v_fma_mix_f32 v101, v82, |v88|, v73 op_sel:[1,0,0] op_sel_hi:[1,0,0]
    v_fma_mix_f32 v102, v83, |v88|, v74 op_sel:[0,0,0] op_sel_hi:[1,0,0]
    v_fma_mix_f32 v103, v83, |v88|, v75 op_sel:[1,0,0] op_sel_hi:[1,0,0]
    s_waitcnt vmcnt(0)

    v_alignbit_b32 v89, v85, s44, 2
    v_lshl_add_u64 v[86:87], v[86:87], 0, v[66:67]
    v_alignbit_b32 v89, v84, v89, 3
    v_lshl_add_u64 v[84:85], v[84:85], 0, s[42:43]
    v_and_b32 v84, -4, v84
    v_and_b32 v85, -4, v85

    v_or3_b32 v13, v13, v84, v85
    v_or3_b32 v13, v13, v86, v87
    v_fma_mix_f32 v96, v84, |v89|, v96 op_sel:[0,0,0] op_sel_hi:[1,0,0]
    v_fma_mix_f32 v97, v84, |v89|, v97 op_sel:[1,0,0] op_sel_hi:[1,0,0]
    v_fma_mix_f32 v98, v85, |v89|, v98 op_sel:[0,0,0] op_sel_hi:[1,0,0]
    v_fma_mix_f32 v99, v85, |v89|, v99 op_sel:[1,0,0] op_sel_hi:[1,0,0]
    v_fma_mix_f32 v100, v86, |v89|, v100 op_sel:[0,0,0] op_sel_hi:[1,0,0]
    v_fma_mix_f32 v101, v86, |v89|, v101 op_sel:[1,0,0] op_sel_hi:[1,0,0]
    v_fma_mix_f32 v102, v87, |v89|, v102 op_sel:[0,0,0] op_sel_hi:[1,0,0]
    v_fma_mix_f32 v103, v87, |v89|, v103 op_sel:[1,0,0] op_sel_hi:[1,0,0]
    v_and_b32 v13, 0x30003, v13
    v_cmp_ne_u32 vcc, 0, v13
    s_cbranch_vccnz L_slow_23
L_ok_25:
    v_permlane16_swap_b32 v96, v100
    v_permlane16_swap_b32 v97, v101
    v_permlane16_swap_b32 v98, v102
    v_permlane16_swap_b32 v99, v103
    v_pk_add_f32 v[96:97], v[96:97], v[100:101]
    v_pk_add_f32 v[98:99], v[98:99], v[102:103]
    v_max_f32 v96, 0, v96
    v_max_f32 v97, 0, v97
    v_max_f32 v98, 0, v98
    v_max_f32 v99, 0, v99
    v_pk_mul_f32 v[96:97], v[96:97], v[96:97]
    v_pk_mul_f32 v[98:99], v[98:99], v[98:99]
    v_cvt_pk_bf16_f32 v96, v96, v97
    v_cvt_pk_bf16_f32 v97, v98, v99
    ds_write_b64 v65, v[96:97]
    s_waitcnt vmcnt(0) lgkmcnt(0)
    s_barrier
    s_endpgm
L_skip:
    s_waitcnt vmcnt(3)
    s_add_u32 m0, s65, 65536
    s_mov_b32 s53, 0
    buffer_load_dwordx4 v5, s[32:35], s53 offen nt lds
    s_waitcnt vmcnt(3)
    s_add_u32 m0, s65, 66560
    s_mov_b32 s53, 8192
    buffer_load_dwordx4 v5, s[32:35], s53 offen nt lds
    v_mov_b32_dpp v60, v206 row_shl:8 row_mask:0xf bank_mask:0xf bound_ctrl:0
    v_cndmask_b32 v62, v206, 0, s[62:63]
    v_mov_b32_dpp v61, v207 row_shl:8 row_mask:0xf bank_mask:0xf bound_ctrl:0
    v_cndmask_b32 v63, v207, 0, s[62:63]
    v_perm_b32 v176, v228, v224, s54
    v_perm_b32 v178, v230, v226, s54
    v_perm_b32 v180, v228, v224, s55
    v_perm_b32 v182, v230, v226, s55
    v_perm_b32 v184, v229, v225, s54
    v_perm_b32 v186, v231, v227, s54
    v_perm_b32 v188, v229, v225, s55
    v_perm_b32 v190, v231, v227, s55
    s_waitcnt vmcnt(3)
    s_add_u32 m0, s65, 98304
    s_mov_b32 s53, 0
    buffer_load_dwordx4 v6, s[28:31], s53 offen nt lds
    s_waitcnt vmcnt(3)
    s_add_u32 m0, s65, 73728
    s_mov_b32 s53, 65536
    buffer_load_dwordx4 v5, s[32:35], s53 offen nt lds
    v_perm_b32 v177, v236, v232, s54
    v_perm_b32 v179, v238, v234, s54
    v_perm_b32 v181, v236, v232, s55
    v_perm_b32 v183, v238, v234, s55
    v_perm_b32 v185, v237, v233, s54
    v_perm_b32 v187, v239, v235, s54
    v_perm_b32 v189, v237, v233, s55
    v_perm_b32 v191, v239, v235, s55
    v_mfma_f32_16x16x32_bf16 v[32:35], v[176:179], v[60:63], v[32:35]
    v_mfma_f32_16x16x32_bf16 v[36:39], v[180:183], v[60:63], v[36:39]
    v_mfma_f32_16x16x32_bf16 v[40:43], v[184:187], v[60:63], v[40:43]
    v_mfma_f32_16x16x32_bf16 v[44:47], v[188:191], v[60:63], v[44:47]
    s_nop 4
    ds_write_b128 v9, v[32:35] offset:0
    ds_write_b128 v9, v[36:39] offset:16
    ds_write_b128 v9, v[40:43] offset:32
    ds_write_b128 v9, v[44:47] offset:48
    v_max_u32 v0, 11, v0
    ds_write_b32 v12, v0
    s_waitcnt vmcnt(3)
    s_add_u32 m0, s65, 99328
    s_mov_b32 s53, 8192
    buffer_load_dwordx4 v6, s[28:31], s53 offen nt lds
    s_waitcnt vmcnt(3)
    s_add_u32 m0, s65, 74752
    s_mov_b32 s53, 73728
    buffer_load_dwordx4 v5, s[32:35], s53 offen nt lds
    s_waitcnt vmcnt(3)
    s_add_u32 m0, s65, 106496
    s_mov_b32 s53, 65536
    buffer_load_dwordx4 v6, s[28:31], s53 offen nt lds
    s_waitcnt vmcnt(3)
    s_add_u32 m0, s65, 81920
    s_mov_b32 s53, 131072
    buffer_load_dwordx4 v5, s[32:35], s53 offen nt lds
    s_waitcnt vmcnt(3)
    s_add_u32 m0, s65, 107520
    s_mov_b32 s53, 73728
    buffer_load_dwordx4 v6, s[28:31], s53 offen nt lds
    s_waitcnt vmcnt(3)
    s_add_u32 m0, s65, 82944
    s_mov_b32 s53, 139264
    buffer_load_dwordx4 v5, s[32:35], s53 offen nt lds
    s_waitcnt vmcnt(3)
    s_add_u32 m0, s65, 114688
    s_mov_b32 s53, 131072
    buffer_load_dwordx4 v6, s[28:31], s53 offen nt lds
    s_waitcnt vmcnt(3)
    s_add_u32 m0, s65, 90112
    s_mov_b32 s53, 196608
    buffer_load_dwordx4 v5, s[32:35], s53 offen nt lds
    v_add_u32 v76, s64, v1
    s_mov_b32 s38, 3145728
    s_mov_b32 s39, 0x20000
    s_mov_b32 s44, 0x10000000
    ds_read_b32 v77, v11 offset:16
    ds_read_b128 v[64:67], v76 offset:17408
    ds_read_b128 v[68:71], v76 offset:21504
    ds_read_b128 v[72:75], v76 offset:25600
    s_waitcnt vmcnt(3)
    s_add_u32 m0, s65, 115712
    s_mov_b32 s53, 139264
    buffer_load_dwordx4 v6, s[28:31], s53 offen nt lds
    s_waitcnt vmcnt(3)
    s_add_u32 m0, s65, 91136
    s_mov_b32 s53, 204800
    buffer_load_dwordx4 v5, s[32:35], s53 offen nt lds
    s_waitcnt vmcnt(3)
    s_add_u32 m0, s66, 122880
    s_mov_b32 s53, s56
    buffer_load_dwordx4 v7, s[28:31], s53 offen nt lds
    s_waitcnt vmcnt(3)
    v_max_u32 v0, 12, v0
    ds_write_b32 v12, v0

L_gs_30:
    s_waitcnt lgkmcnt(0)
    v_cmp_gt_u32 vcc, 3, v77
    v_readfirstlane_b32 s42, v73
    v_readfirstlane_b32 s43, v74
    s_cbranch_vccnz L_gr_32
L_gk_31:

    s_mov_b32 s53, 0
    buffer_load_dwordx4 v[80:83], v64, s[36:39], s53 offen sc1
    s_mov_b32 s53, 114688
    buffer_load_dwordx4 v[84:87], v64, s[36:39], s53 offen sc1
    s_mov_b32 vcc_lo, 0xffff0000
    s_mov_b32 vcc_hi, vcc_lo
    v_cndmask_b32 v72, 0, v68, vcc
    v_cndmask_b32 v73, 0, v69, vcc
    v_cndmask_b32 v74, 0, v70, vcc
    v_cndmask_b32 v75, 0, v71, vcc
    v_cndmask_b32 v68, v68, 0, vcc
    v_cndmask_b32 v69, v69, 0, vcc
    v_cndmask_b32 v70, v70, 0, vcc
    v_cndmask_b32 v71, v71, 0, vcc
    s_waitcnt vmcnt(4)
    v_max_u32 v0, 13, v0
    ds_write_b32 v12, v0
    s_waitcnt vmcnt(3)
    v_max_u32 v0, 14, v0
    ds_write_b32 v12, v0
    s_waitcnt vmcnt(2)
    v_max_u32 v0, 15, v0
    ds_write_b32 v12, v0
    s_waitcnt vmcnt(1)

    v_alignbit_b32 v88, v81, s44, 2
    v_lshl_add_u64 v[82:83], v[82:83], 0, v[66:67]
    v_alignbit_b32 v88, v80, v88, 3
    v_lshl_add_u64 v[80:81], v[80:81], 0, s[42:43]
    v_and_b32 v80, -4, v80
    v_and_b32 v81, -4, v81

    v_or3_b32 v13, v80, v81, v82
    v_or_b32 v13, v13, v83
    v_fma_mix_f32 v96, v80, |v88|, v68 op_sel:[0,0,0] op_sel_hi:[1,0,0]
    v_fma_mix_f32 v97, v80, |v88|, v69 op_sel:[1,0,0] op_sel_hi:[1,0,0]
    v_fma_mix_f32 v98, v81, |v88|, v70 op_sel:[0,0,0] op_sel_hi:[1,0,0]
    v_fma_mix_f32 v99, v81, |v88|, v71 op_sel:[1,0,0] op_sel_hi:[1,0,0]
    v_fma_mix_f32 v100, v82, |v88|, v72 op_sel:[0,0,0] op_sel_hi:[1,0,0]
    v_fma_mix_f32 v101, v82, |v88|, v73 op_sel:[1,0,0] op_sel_hi:[1,0,0]
    v_fma_mix_f32 v102, v83, |v88|, v74 op_sel:[0,0,0] op_sel_hi:[1,0,0]
    v_fma_mix_f32 v103, v83, |v88|, v75 op_sel:[1,0,0] op_sel_hi:[1,0,0]
    s_waitcnt vmcnt(0)

    v_alignbit_b32 v89, v85, s44, 2
    v_lshl_add_u64 v[86:87], v[86:87], 0, v[66:67]
    v_alignbit_b32 v89, v84, v89, 3
    v_lshl_add_u64 v[84:85], v[84:85], 0, s[42:43]
    v_and_b32 v84, -4, v84
    v_and_b32 v85, -4, v85

    v_or3_b32 v13, v13, v84, v85
    v_or3_b32 v13, v13, v86, v87
    v_fma_mix_f32 v96, v84, |v89|, v96 op_sel:[0,0,0] op_sel_hi:[1,0,0]
    v_fma_mix_f32 v97, v84, |v89|, v97 op_sel:[1,0,0] op_sel_hi:[1,0,0]
    v_fma_mix_f32 v98, v85, |v89|, v98 op_sel:[0,0,0] op_sel_hi:[1,0,0]
    v_fma_mix_f32 v99, v85, |v89|, v99 op_sel:[1,0,0] op_sel_hi:[1,0,0]
    v_fma_mix_f32 v100, v86, |v89|, v100 op_sel:[0,0,0] op_sel_hi:[1,0,0]
    v_fma_mix_f32 v101, v86, |v89|, v101 op_sel:[1,0,0] op_sel_hi:[1,0,0]
    v_fma_mix_f32 v102, v87, |v89|, v102 op_sel:[0,0,0] op_sel_hi:[1,0,0]
    v_fma_mix_f32 v103, v87, |v89|, v103 op_sel:[1,0,0] op_sel_hi:[1,0,0]
    v_and_b32 v13, 0x30003, v13
    v_cmp_ne_u32 vcc, 0, v13
    s_cbranch_vccnz L_slow_33
L_ok_35:
    v_permlane16_swap_b32 v96, v100
    v_permlane16_swap_b32 v97, v101
    v_permlane16_swap_b32 v98, v102
    v_permlane16_swap_b32 v99, v103
    v_pk_add_f32 v[96:97], v[96:97], v[100:101]
    v_pk_add_f32 v[98:99], v[98:99], v[102:103]
    v_max_f32 v96, 0, v96
    v_max_f32 v97, 0, v97
    v_max_f32 v98, 0, v98
    v_max_f32 v99, 0, v99
    v_pk_mul_f32 v[96:97], v[96:97], v[96:97]
    v_pk_mul_f32 v[98:99], v[98:99], v[98:99]
    v_cvt_pk_bf16_f32 v96, v96, v97
    v_cvt_pk_bf16_f32 v97, v98, v99
    ds_write_b64 v65, v[96:97]
    s_waitcnt vmcnt(0) lgkmcnt(0)
    s_barrier
    s_endpgm
L_helper:

    s_lshr_b32 s3, s64, 10
    s_sub_u32 s56, s3, 4
    v_and_b32 v0, 63, v0
    s_mov_b32 s74, 0x400000
    s_mov_b32 s75, 0
    s_lshl2_add_u32 s67, s3, 150272
    v_mov_b32 v12, s67
    v_and_b32 v11, 3, v0
    v_lshlrev_b32 v11, 2, v11
    v_add_u32 v11, 150272, v11
    v_lshrrev_b32 v62, 5, v0

    s_bfe_u32 s6, s2, 0x10005
    s_bfe_u32 s7, s2, 0x10006
    s_lshl1_add_u32 s6, s6, s7
    s_xor_b32 s6, s6, 2
    s_lshr_b32 s7, s2, 7
    s_lshl_b32 s7, s7, 5
    s_and_b32 s73, s2, 31
    s_or_b32 s7, s7, s73
    s_xor_b32 s73, s6, 1
    s_lshl_b32 s73, s73, 6
    s_or_b32 s73, s73, s7
    s_lshr_b32 s72, s7, 3
    s_lshl2_add_u32 s72, s72, s6
    s_and_b32 s7, s2, 7
    s_lshl3_add_u32 s72, s72, s7

    s_lshr_b32 s7, s2, 5
    s_mul_i32 s6, s7, 0
    s_add_u32 s6, s6, s2
    s_and_b32 s6, s6, 31
    s_lshl3_add_u32 s73, s6, s7
    s_waitcnt lgkmcnt(0)
    s_load_dword s52, s[36:37], 0
    s_mov_b32 s55, 0
    s_bfe_u32 s18, s2, 0x20003

    s_mov_b32 s38, 3145728
    s_mov_b32 s39, 0x20000
    s_mov_b32 s42, 7168
    s_mov_b32 s43, 0x20000
    s_mov_b32 s54, 0x3e0293ee
    s_lshr_b32 s6, s73, 3
    v_lshlrev_b32 v1, 4, v0
    v_and_b32 v3, 15, v0
    v_lshrrev_b32 v4, 4, v0
    v_mov_b32 v2, 0xffffff00
    v_mov_b32 v63, 2147483632
    v_and_b32 v60, 7, v0
    v_lshrrev_b32 v58, 2, v3
    v_and_b32 v59, 3, v3
    v_cmp_gt_u32 s[62:63], 8, v3
    s_and_b32 s67, s2, 3
    s_lshl_b32 s67, s67, 12
    s_lshr_b32 s68, s2, 2
    s_lshl_b32 s68, s68, 5
    v_lshl_add_u32 v51, v59, 1, v62
    v_lshl_add_u32 v19, v51, 2, s68
    v_and_b32 v51, 1, v4
    v_lshl_add_u32 v51, v51, 11, s67
    v_add_u32 v20, v51, v19
    v_and_b32 v57, 1, v4
    v_lshlrev_b32 v53, 6, v58
    v_lshl_add_u32 v53, v57, 5, v53
    v_lshl_add_u32 v53, v59, 3, v53
    s_mul_i32 s7, s6, 7
    s_lshr_b32 s7, s7, 1
    s_lshl_b32 s67, s7, 6
    v_add_u32 v51, s67, v53
    buffer_load_dwordx2 v[48:49], v51, s[40:43], 0 offen
    buffer_load_dword v18, v20, s[24:27], 0 offen
    global_load_dword v19, v19, s[44:45]
    s_mul_i32 s67, s56, 544
    s_add_u32 s67, s67, 143488
    v_mul_u32_u24 v51, 272, v62
    v_add3_u32 v24, v51, v53, s67
    s_and_b32 s67, s6, 1
    s_lshl_b32 s67, s67, 5
    v_subrev_u32 v53, s67, v53
    v_and_b32 v53, 0xff, v53
    v_mov_b32 v51, 224
    v_cmp_gt_u32 s[64:65], v51, v53
    s_mul_i32 s67, s56, 1088
    v_mul_u32_u24 v51, 544, v62
    s_add_u32 s68, s67, 145920
    v_add3_u32 v38, v51, v53, s68
    v_lshlrev_b32 v54, 4, v3
    v_lshl_add_u32 v53, v57, 3, v54
    s_add_u32 s68, s67, 145664
    v_add3_u32 v27, v51, v53, s68
    s_mul_i32 s68, s56, 2112
    v_mul_u32_u24 v51, 528, v4
    v_lshl_add_u32 v51, v3, 5, v51
    v_add_u32 v26, s68, v51
    s_mul_i32 s68, s56, 4128
    s_add_u32 s68, s68, 126976
    v_mul_u32_u24 v51, 2064, v62
    v_add3_u32 v23, v51, v52, s68
    s_lshl_b32 s68, s5, 16
    s_lshl1_add_u32 s69, s4, s56
    s_lshl_b32 s69, s69, 6
    s_add_u32 s68, s68, s69
    s_add_u32 s68, s68, 262144
    s_mul_i32 s69, s18, 57344
    s_lshl1_add_u32 s70, s55, s56
    s_lshl_b32 s70, s70, 9
    s_add_u32 s69, s69, s70
    s_add_u32 s69, s69, 524288
    s_cmp_lt_u32 s56, 2
    s_cselect_b32 s68, s68, 2147483632
    s_cselect_b32 s55, s55, 63
    s_cmp_lt_u32 s55, 56
    s_cselect_b32 s69, s69, 2147483632
    v_lshlrev_b32 v50, 4, v4
    v_lshl_add_u32 v51, v3, 13, v50
    v_add_u32 v51, s68, v51
    v_cndmask_b32 v5, v63, v51, s[62:63]
    v_lshl_add_u32 v51, v3, 6, v50
    v_add_u32 v51, s69, v51
    v_cndmask_b32 v6, v63, v51, s[62:63]
    s_lshr_b32 s67, s72, 3
    s_lshl2_add_u32 s67, s67, s56
    s_lshl_b32 s67, s67, 9
    s_add_u32 s67, s67, 262144
    v_lshl_add_u32 v51, v57, 16, v54
    v_lshl_add_u32 v51, v62, 8, v51
    v_add_u32 v7, s67, v51
    s_lshl2_add_u32 s67, s7, s56
    s_lshl_b32 s67, s67, 7
    s_add_u32 s67, s67, 524288
    v_mul_u32_u24 v51, 57344, v57
    v_lshl_add_u32 v51, v58, 9, v51
    v_lshl_add_u32 v51, v62, 6, v51
    v_lshl_add_u32 v51, v59, 4, v51
    v_add_u32 v8, s67, v51
    s_lshl2_add_u32 s67, s6, s56
    s_lshl_b32 s67, s67, 9
    s_add_u32 s67, s67, 1572864
    v_lshl_add_u32 v51, v62, 0, 0
    v_lshl_add_u32 v51, v51, 8, v54
    v_add_u32 v9, s67, v51
    s_and_b32 s69, s56, 1
    s_lshl4_add_u32 s67, s2, s69
    s_lshl_b32 s67, s67, 7
    s_add_u32 s67, s67, 1048576
    v_lshrrev_b32 v55, 3, v0
    v_lshl_add_u32 v51, v55, 4, v60
    v_lshl_add_u32 v17, v51, 4, s67
    s_and_b32 s67, s72, 31
    s_lshr_b32 s68, s72, 5
    s_lshl3_add_u32 s67, s67, s68
    s_lshl_b32 s67, s67, 1
    s_add_u32 s67, s67, s69
    s_lshl_b32 s67, s67, 7
    s_add_u32 s67, s67, 1572864
    v_add_u32 v51, s67, v1
    v_cmp_gt_u32 vcc, 8, v0
    s_nop 1
    v_cndmask_b32 v231, v63, v51, vcc
    s_and_b32 s67, s72, 24
    s_lshl2_add_u32 s67, s69, s67
    s_lshl3_add_u32 s67, s67, s68
    s_lshl_b32 s67, s67, 8
    s_add_u32 s67, s67, 1571072
    v_lshl_add_u32 v51, v4, 11, v54
    v_add_u32 v230, s67, v51
    s_lshr_b32 s67, s2, 3
    s_lshl4_add_u32 s67, s67, s69
    s_lshl_b32 s67, s67, 6
    s_add_u32 s67, s67, 32768
    v_lshl_add_u32 v51, v60, 3, v55
    v_lshl_add_u32 v51, v51, 4, s67
    s_andn2_b32 s67, s67, 0xfff
    v_lshl_add_u32 v55, v52, 3, s67
    v_cmp_eq_u32 vcc, 0, v62
    s_nop 1
    v_cndmask_b32 v10, v55, v51, vcc
    s_and_b32 s67, s2, 7
    s_lshl_b32 s67, s67, 2
    v_lshl_add_u32 v248, v4, 5, s67
    s_lshl_b32 s68, s2, 7
    s_add_u32 s68, s68, 32768
    s_cmp_eq_u32 s56, 0
    s_cselect_b32 s68, s68, 2147483632
    v_add_u32 v51, s68, v1
    v_cmp_gt_u32 vcc, 8, v0
    s_nop 1
    v_cndmask_b32 v16, v63, v51, vcc
    s_lshl_b32 s68, s69, 7
    s_add_u32 s68, s68, 150016
    v_lshl_add_u32 v25, v4, 5, s68
    v_lshlrev_b32 v51, 5, v60
    v_add_u32 v39, 150016, v51
    s_lshl_b32 s67, s2, 7
    s_add_u32 s67, s67, 2097152
    v_lshrrev_b32 v54, 3, v0
    v_lshlrev_b32 v51, 15, v54
    v_lshl_add_u32 v51, v60, 4, v51
    v_add_u32 v13, s67, v51
    s_lshr_b32 s67, s2, 3
    s_lshl1_add_u32 s67, s67, s69
    s_lshl_b32 s67, s67, 5
    s_and_b32 s68, s2, 7
    s_or_b32 s67, s67, s68
    s_lshl_b32 s67, s67, 8
    s_add_u32 s67, s67, 1048576
    v_lshl_add_u32 v51, v4, 7, v3
    v_lshl_add_u32 v15, v51, 4, s67
    s_lshl2_add_u32 s68, s73, s56
    s_lshl_b32 s68, s68, 10
    s_add_u32 s68, s68, 2097152
    v_lshl_add_u32 v51, v3, 6, v50
    v_add_u32 v14, s68, v51
    v_lshl_add_u32 v50, v4, 2, v58
    v_and_b32 v51, 6, v50
    s_and_b32 s67, s56, 1
    s_lshl_b32 s67, s67, 2
    v_lshrrev_b32 v55, 1, v59
    v_and_b32 v56, 1, v59
    v_lshlrev_b32 v56, 3, v56
    v_add_u32 v57, s67, v55
    v_xor_b32 v57, v57, v51
    v_lshl_add_u32 v57, v57, 4, v56
    v_lshl_add_u32 v21, v50, 7, v57
    v_xor_b32 v37, 32, v21
    v_mul_u32_u24 v50, 2064, v60
    v_lshl_add_u32 v51, v4, 3, v50
    v_add_u32 v22, 126976, v51
    v_mul_u32_u24 v50, 544, v60
    v_and_b32 v51, 8, v0
    v_lshl_add_u32 v50, v51, 5, v50
    v_lshl_add_u32 v51, v4, 4, v50
    v_add_u32 v28, 145664, v51
    s_lshl_b32 s67, s56, 2
    v_add_u32 v55, s67, v55
    v_and_b32 v57, 1, v4
    v_lshlrev_b32 v51, 1, v57
    v_lshl_add_u32 v51, v58, 2, v51
    v_xor_b32 v51, v51, v55
    v_lshl_add_u32 v51, v51, 4, v56
    v_lshl_add_u32 v51, v4, 9, v51
    v_lshl_add_u32 v51, v58, 11, v51
    v_add_u32 v29, 65536, v51
    v_xor_b32 v30, 32, v29
    v_lshlrev_b32 v51, 3, v57
    v_lshl_add_u32 v51, v58, 1, v51
    v_xor_b32 v51, v51, v55
    v_lshl_add_u32 v51, v51, 4, v56
    v_lshl_add_u32 v51, v58, 8, v51
    v_add_u32 v51, 98304, v51
    v_lshl_add_u32 v31, v4, 11, v51
    v_lshl_add_u32 v33, v57, 11, v51
    v_xor_b32 v32, 32, v31
    v_xor_b32 v34, 32, v33
    s_waitcnt lgkmcnt(0)
    s_mul_i32 s52, s52, 0x9E3779B1
    s_add_u32 s52, s52, 0x7F4A7C15
    s_and_b32 s48, s52, 0xff
    s_bfe_u32 s49, s52, 0x80008
    s_bfe_u32 s50, s52, 0x80010
    s_lshr_b32 s51, s52, 24
    s_sub_u32 s58, 0, s48
    s_subb_u32 s59, 0, s49
    s_sub_u32 s60, 0, s50
    s_subb_u32 s61, 0, s51
    s_and_b32 s28, s48, 3
    s_lshl_b32 s28, s28, 16
    s_and_b32 s29, s48, 12
    s_lshl_b32 s29, s29, 14
    s_sub_u32 s30, 0, s28
    s_subb_u32 s31, 0, s29
    s_mov_b32 s32, 0x10000000
    s_mov_b32 s33, 0xfffcfffc
    s_mov_b64 s[72:73], s[46:47]
    s_getreg_b32 s19, hwreg(HW_REG_XCC_ID, 0, 24)
    s_lshl_b32 s19, s19, 8

    s_waitcnt vmcnt(3)
    v_lshlrev_b32 v80, 16, v64
    v_and_b32 v81, 0xffff0000, v64
    v_lshlrev_b32 v82, 16, v65
    v_and_b32 v83, 0xffff0000, v65
    v_lshlrev_b32 v84, 16, v66
    v_and_b32 v85, 0xffff0000, v66
    v_lshlrev_b32 v86, 16, v67
    v_and_b32 v87, 0xffff0000, v67
    v_lshlrev_b32 v88, 16, v68
    v_and_b32 v89, 0xffff0000, v68
    v_lshlrev_b32 v90, 16, v69
    v_and_b32 v91, 0xffff0000, v69
    v_lshlrev_b32 v92, 16, v70
    v_and_b32 v93, 0xffff0000, v70
    v_lshlrev_b32 v94, 16, v71
    v_and_b32 v95, 0xffff0000, v71
    v_lshlrev_b32 v96, 16, v72
    v_and_b32 v97, 0xffff0000, v72
    v_lshlrev_b32 v98, 16, v73
    v_and_b32 v99, 0xffff0000, v73
    v_lshlrev_b32 v100, 16, v74
    v_and_b32 v101, 0xffff0000, v74
    v_lshlrev_b32 v102, 16, v75
    v_and_b32 v103, 0xffff0000, v75
    v_lshlrev_b32 v104, 16, v76
    v_and_b32 v105, 0xffff0000, v76
    v_lshlrev_b32 v106, 16, v77
    v_and_b32 v107, 0xffff0000, v77
    v_lshlrev_b32 v108, 16, v78
    v_and_b32 v109, 0xffff0000, v78
    v_lshlrev_b32 v110, 16, v79
    v_and_b32 v111, 0xffff0000, v79
    v_add_f32 v112, v80, v96
    v_add_f32 v113, v81, v97
    v_add_f32 v114, v82, v98
    v_add_f32 v115, v83, v99
    v_add_f32 v116, v84, v100
    v_add_f32 v117, v85, v101
    v_add_f32 v118, v86, v102
    v_add_f32 v119, v87, v103
    v_add_f32 v120, v88, v104
    v_add_f32 v121, v89, v105
    v_add_f32 v122, v90, v106
    v_add_f32 v123, v91, v107
    v_add_f32 v124, v92, v108
    v_add_f32 v125, v93, v109
    v_add_f32 v126, v94, v110
    v_add_f32 v127, v95, v111
    v_add_f32 v112, v112, v120
    v_add_f32 v113, v113, v121
    v_add_f32 v114, v114, v122
    v_add_f32 v115, v115, v123
    v_add_f32 v116, v116, v124
    v_add_f32 v117, v117, v125
    v_add_f32 v118, v118, v126
    v_add_f32 v119, v119, v127
    v_add_f32 v112, v112, v116
    v_add_f32 v113, v113, v117
    v_add_f32 v114, v114, v118
    v_add_f32 v115, v115, v119
    v_add_f32 v112, v112, v114
    v_add_f32 v113, v113, v115
    v_add_f32 v112, v112, v113
    s_nop 1
    v_add_f32_dpp v112, v112, v112 quad_perm:[1,0,3,2] row_mask:0xf bank_mask:0xf
    s_nop 1
    v_add_f32_dpp v112, v112, v112 quad_perm:[2,3,0,1] row_mask:0xf bank_mask:0xf
    s_nop 1
    v_add_f32_dpp v112, v112, v112 row_half_mirror row_mask:0xf bank_mask:0xf
    s_nop 1
    v_add_f32_dpp v112, v112, v112 row_mirror row_mask:0xf bank_mask:0xf
    v_mov_b32 v50, v112
    s_nop 1
    v_permlane16_swap_b32 v112, v50
    v_add_f32 v112, v112, v50
    v_mul_f32 v112, 0x3a800000, v112
    v_sub_f32 v80, v80, v112
    v_sub_f32 v81, v81, v112
    v_sub_f32 v82, v82, v112
    v_sub_f32 v83, v83, v112
    v_sub_f32 v84, v84, v112
    v_sub_f32 v85, v85, v112
    v_sub_f32 v86, v86, v112
    v_sub_f32 v87, v87, v112
    v_sub_f32 v88, v88, v112
    v_sub_f32 v89, v89, v112
    v_sub_f32 v90, v90, v112
    v_sub_f32 v91, v91, v112
    v_sub_f32 v92, v92, v112
    v_sub_f32 v93, v93, v112
    v_sub_f32 v94, v94, v112
    v_sub_f32 v95, v95, v112
    v_sub_f32 v96, v96, v112
    v_sub_f32 v97, v97, v112
    v_sub_f32 v98, v98, v112
    v_sub_f32 v99, v99, v112
    v_sub_f32 v100, v100, v112
    v_sub_f32 v101, v101, v112
    v_sub_f32 v102, v102, v112
    v_sub_f32 v103, v103, v112
    v_sub_f32 v104, v104, v112
    v_sub_f32 v105, v105, v112
    v_sub_f32 v106, v106, v112
    v_sub_f32 v107, v107, v112
    v_sub_f32 v108, v108, v112
    v_sub_f32 v109, v109, v112
    v_sub_f32 v110, v110, v112
    v_sub_f32 v111, v111, v112
    v_mul_f32 v112, v80, v80
    v_mul_f32 v113, v88, v88
    v_mul_f32 v114, v96, v96
    v_mul_f32 v115, v104, v104
    v_fmac_f32 v112, v81, v81
    v_fmac_f32 v113, v89, v89
    v_fmac_f32 v114, v97, v97
    v_fmac_f32 v115, v105, v105
    v_fmac_f32 v112, v82, v82
    v_fmac_f32 v113, v90, v90
    v_fmac_f32 v114, v98, v98
    v_fmac_f32 v115, v106, v106
    v_fmac_f32 v112, v83, v83
    v_fmac_f32 v113, v91, v91
    v_fmac_f32 v114, v99, v99
    v_fmac_f32 v115, v107, v107
    v_fmac_f32 v112, v84, v84
    v_fmac_f32 v113, v92, v92
    v_fmac_f32 v114, v100, v100
    v_fmac_f32 v115, v108, v108
    v_fmac_f32 v112, v85, v85
    v_fmac_f32 v113, v93, v93
    v_fmac_f32 v114, v101, v101
    v_fmac_f32 v115, v109, v109
    v_fmac_f32 v112, v86, v86
    v_fmac_f32 v113, v94, v94
    v_fmac_f32 v114, v102, v102
    v_fmac_f32 v115, v110, v110
    v_fmac_f32 v112, v87, v87
    v_fmac_f32 v113, v95, v95
    v_fmac_f32 v114, v103, v103
    v_fmac_f32 v115, v111, v111
    v_add_f32 v112, v112, v114
    v_add_f32 v113, v113, v115
    v_add_f32 v112, v112, v113
    s_nop 1
    v_add_f32_dpp v112, v112, v112 quad_perm:[1,0,3,2] row_mask:0xf bank_mask:0xf
    s_nop 1
    v_add_f32_dpp v112, v112, v112 quad_perm:[2,3,0,1] row_mask:0xf bank_mask:0xf
    s_nop 1
    v_add_f32_dpp v112, v112, v112 row_half_mirror row_mask:0xf bank_mask:0xf
    s_nop 1
    v_add_f32_dpp v112, v112, v112 row_mirror row_mask:0xf bank_mask:0xf
    v_mov_b32 v50, v112
    s_nop 1
    v_permlane16_swap_b32 v112, v50
    v_add_f32 v112, v112, v50
    v_mov_b32 v113, 0x3727c5ac
    v_fmac_f32 v113, 0x3a800000, v112
    v_rsq_f32 v113, v113
    s_nop 0
    v_mul_f32 v80, v80, v113
    v_mul_f32 v81, v81, v113
    v_mul_f32 v82, v82, v113
    v_mul_f32 v83, v83, v113
    v_mul_f32 v84, v84, v113
    v_mul_f32 v85, v85, v113
    v_mul_f32 v86, v86, v113
    v_mul_f32 v87, v87, v113
    v_cvt_pk_bf16_f32 v116, v80, v81
    v_cvt_pk_bf16_f32 v117, v82, v83
    v_cvt_pk_bf16_f32 v118, v84, v85
    v_cvt_pk_bf16_f32 v119, v86, v87
    ds_write_b128 v23, v[116:119]
    v_mov_b32 v50, 1
    ds_write_b32 v12, v50
    v_mul_f32 v88, v88, v113
    v_mul_f32 v89, v89, v113
    v_mul_f32 v90, v90, v113
    v_mul_f32 v91, v91, v113
    v_mul_f32 v92, v92, v113
    v_mul_f32 v93, v93, v113
    v_mul_f32 v94, v94, v113
    v_mul_f32 v95, v95, v113
    v_cvt_pk_bf16_f32 v88, v88, v89
    v_cvt_pk_bf16_f32 v89, v90, v91
    v_cvt_pk_bf16_f32 v90, v92, v93
    v_cvt_pk_bf16_f32 v91, v94, v95
    ds_write_b128 v23, v[88:91] offset:512
    v_mul_f32 v96, v96, v113
    v_mul_f32 v97, v97, v113
    v_mul_f32 v98, v98, v113
    v_mul_f32 v99, v99, v113
    v_mul_f32 v100, v100, v113
    v_mul_f32 v101, v101, v113
    v_mul_f32 v102, v102, v113
    v_mul_f32 v103, v103, v113
    v_cvt_pk_bf16_f32 v96, v96, v97
    v_cvt_pk_bf16_f32 v97, v98, v99
    v_cvt_pk_bf16_f32 v98, v100, v101
    v_cvt_pk_bf16_f32 v99, v102, v103
    ds_write_b128 v23, v[96:99] offset:1024
    v_mul_f32 v104, v104, v113
    v_mul_f32 v105, v105, v113
    v_mul_f32 v106, v106, v113
    v_mul_f32 v107, v107, v113
    v_mul_f32 v108, v108, v113
    v_mul_f32 v109, v109, v113
    v_mul_f32 v110, v110, v113
    v_mul_f32 v111, v111, v113
    v_cvt_pk_bf16_f32 v104, v104, v105
    v_cvt_pk_bf16_f32 v105, v106, v107
    v_cvt_pk_bf16_f32 v106, v108, v109
    v_cvt_pk_bf16_f32 v107, v110, v111
    ds_write_b128 v23, v[104:107] offset:1536
    v_lshlrev_b32 v252, 3, v4
    v_lshlrev_b32 v226, 3, v59

    v_bfe_u32 v252, s52, v252, 8
    v_mul_u32_u24 v252, 0x4001, v252
    v_lshrrev_b32 v253, 4, v252
    v_and_b32 v252, 0x30003, v252
    v_and_b32 v253, 0x30003, v253

    v_bfe_u32 v226, s52, v226, 8
    v_mul_u32_u24 v226, 0x4001, v226
    v_lshrrev_b32 v227, 4, v226
    v_and_b32 v226, 0x30003, v226
    v_and_b32 v227, 0x30003, v227

    v_sub_co_u32 v228, vcc, 0, v226
    s_nop 1
    v_subb_co_u32 v229, vcc, 0, v227, vcc

L_pw_36:

    ds_read_b32 v50, v11 offset:16
    s_sub_u32 s74, s74, 1
    s_cmp_lt_i32 s74, 0
    s_cbranch_scc1 L_pk_37
    s_waitcnt lgkmcnt(0)
    v_cmp_gt_u32 vcc, 1, v50
    s_cbranch_vccnz L_pw_36

L_pk_37:
    ds_read2_b64 v[128:131], v22 offset0:0 offset1:4
    ds_read2_b64 v[132:135], v22 offset0:8 offset1:12
    ds_read2_b64 v[136:139], v22 offset0:16 offset1:20
    ds_read2_b64 v[140:143], v22 offset0:24 offset1:28
    ds_read2_b64 v[144:147], v22 offset0:32 offset1:36
    ds_read2_b64 v[148:151], v22 offset0:40 offset1:44
    ds_read2_b64 v[152:155], v22 offset0:48 offset1:52
    ds_read2_b64 v[156:159], v22 offset0:56 offset1:60
    s_cmp_ge_u32 s56, 2
    s_cbranch_scc1 L_skh_38
L_pw_39:

    ds_read_b32 v50, v11 offset:0
    s_sub_u32 s74, s74, 1
    s_cmp_lt_i32 s74, 0
    s_cbranch_scc1 L_pk_40
    s_waitcnt lgkmcnt(0)
    v_cmp_gt_u32 vcc, 1, v50
    s_cbranch_vccnz L_pw_39

L_pk_40:
    ds_read_b64_tr_b16 v[64:65], v21 offset:0
    ds_read_b64_tr_b16 v[66:67], v21 offset:2048
    ds_read_b64_tr_b16 v[68:69], v37 offset:0
    ds_read_b64_tr_b16 v[70:71], v37 offset:2048
    ds_read_b64_tr_b16 v[72:73], v21 offset:4096
    ds_read_b64_tr_b16 v[74:75], v21 offset:6144
    ds_read_b64_tr_b16 v[76:77], v37 offset:4096
    ds_read_b64_tr_b16 v[78:79], v37 offset:6144
    ds_read_b64_tr_b16 v[80:81], v21 offset:8192
    ds_read_b64_tr_b16 v[82:83], v21 offset:10240
    ds_read_b64_tr_b16 v[84:85], v37 offset:8192
    ds_read_b64_tr_b16 v[86:87], v37 offset:10240
    s_waitcnt lgkmcnt(10)
    v_mfma_f32_16x16x32_bf16 v[52:55], v[64:67], v[128:131], 0
    s_waitcnt lgkmcnt(8)
    v_mfma_f32_16x16x32_bf16 v[56:59], v[68:71], v[128:131], 0
    ds_read_b64_tr_b16 v[88:89], v21 offset:12288
    ds_read_b64_tr_b16 v[90:91], v21 offset:14336
    ds_read_b64_tr_b16 v[92:93], v37 offset:12288
    ds_read_b64_tr_b16 v[94:95], v37 offset:14336
    s_waitcnt lgkmcnt(10)
    v_mfma_f32_16x16x32_bf16 v[52:55], v[72:75], v[132:135], v[52:55]
    s_waitcnt lgkmcnt(8)
    v_mfma_f32_16x16x32_bf16 v[56:59], v[76:79], v[132:135], v[56:59]
    ds_read_b64_tr_b16 v[96:97], v21 offset:16384
    ds_read_b64_tr_b16 v[98:99], v21 offset:18432
    ds_read_b64_tr_b16 v[100:101], v37 offset:16384
    ds_read_b64_tr_b16 v[102:103], v37 offset:18432
    s_waitcnt lgkmcnt(10)
    v_mfma_f32_16x16x32_bf16 v[52:55], v[80:83], v[136:139], v[52:55]
    s_waitcnt lgkmcnt(8)
    v_mfma_f32_16x16x32_bf16 v[56:59], v[84:87], v[136:139], v[56:59]
    ds_read_b64_tr_b16 v[104:105], v21 offset:20480
    ds_read_b64_tr_b16 v[106:107], v21 offset:22528
    ds_read_b64_tr_b16 v[108:109], v37 offset:20480
    ds_read_b64_tr_b16 v[110:111], v37 offset:22528
    s_waitcnt lgkmcnt(10)
    v_mfma_f32_16x16x32_bf16 v[52:55], v[88:91], v[140:143], v[52:55]
    s_waitcnt lgkmcnt(8)
    v_mfma_f32_16x16x32_bf16 v[56:59], v[92:95], v[140:143], v[56:59]
    ds_read_b64_tr_b16 v[112:113], v21 offset:24576
    ds_read_b64_tr_b16 v[114:115], v21 offset:26624
    ds_read_b64_tr_b16 v[116:117], v37 offset:24576
    ds_read_b64_tr_b16 v[118:119], v37 offset:26624
    s_waitcnt lgkmcnt(10)
    v_mfma_f32_16x16x32_bf16 v[52:55], v[96:99], v[144:147], v[52:55]
    s_waitcnt lgkmcnt(8)
    v_mfma_f32_16x16x32_bf16 v[56:59], v[100:103], v[144:147], v[56:59]
    ds_read_b64_tr_b16 v[120:121], v21 offset:28672
    ds_read_b64_tr_b16 v[122:123], v21 offset:30720
    ds_read_b64_tr_b16 v[124:125], v37 offset:28672
    ds_read_b64_tr_b16 v[126:127], v37 offset:30720
    s_waitcnt lgkmcnt(10)
    v_mfma_f32_16x16x32_bf16 v[52:55], v[104:107], v[148:151], v[52:55]
    s_waitcnt lgkmcnt(8)
    v_mfma_f32_16x16x32_bf16 v[56:59], v[108:111], v[148:151], v[56:59]
    s_waitcnt lgkmcnt(6)
    v_mfma_f32_16x16x32_bf16 v[52:55], v[112:115], v[152:155], v[52:55]
    s_waitcnt lgkmcnt(4)
    v_mfma_f32_16x16x32_bf16 v[56:59], v[116:119], v[152:155], v[56:59]
    s_waitcnt lgkmcnt(2)
    v_mfma_f32_16x16x32_bf16 v[52:55], v[120:123], v[156:159], v[52:55]
    s_waitcnt lgkmcnt(0)
    v_mfma_f32_16x16x32_bf16 v[56:59], v[124:127], v[156:159], v[56:59]
    s_nop 5
    v_max3_f32 v50, |v52|, |v53|, |v54|
    s_nop 0
    v_max3_f32 v50, v50, |v55|, |v56|
    v_max3_f32 v50, v50, |v57|, |v58|
    v_max_f32 v50, v50, |v59|
    v_and_b32 v50, 0x78000000, v50
    v_sub_u32 v51, 0x7e802c00, v50
    v_pk_mul_f32 v[52:53], v[50:51], v[52:53] op_sel:[1,0] op_sel_hi:[1,1]
    v_pk_mul_f32 v[54:55], v[50:51], v[54:55] op_sel:[1,0] op_sel_hi:[1,1]
    v_pk_mul_f32 v[56:57], v[50:51], v[56:57] op_sel:[1,0] op_sel_hi:[1,1]
    v_pk_mul_f32 v[58:59], v[50:51], v[58:59] op_sel:[1,0] op_sel_hi:[1,1]
    v_bfe_u32 v51, v50, 27, 2
    v_lshrrev_b32 v50, 29, v50
    v_cvt_pkrtz_f16_f32 v52, v52, v53
    v_cvt_pkrtz_f16_f32 v53, v54, v55
    v_cvt_pkrtz_f16_f32 v54, v56, v57
    v_cvt_pkrtz_f16_f32 v55, v58, v59
    v_or_b32 v50, s28, v50
    v_or_b32 v51, s29, v51
    v_and_or_b32 v52, v52, s33, v50
    v_and_or_b32 v53, v53, s33, v51
    v_and_or_b32 v54, v54, s33, v252
    v_and_or_b32 v55, v55, s33, v253
L_skh_38:
    buffer_store_dwordx4 v[52:55], v5, s[36:39], 0 offen sc1
L_pw_41:

    ds_read_b32 v50, v11 offset:0
    s_sub_u32 s74, s74, 1
    s_cmp_lt_i32 s74, 0
    s_cbranch_scc1 L_pk_42
    s_waitcnt lgkmcnt(0)
    v_cmp_gt_u32 vcc, 2, v50
    s_cbranch_vccnz L_pw_41

L_pk_42:
    s_mov_b32 s53, 0
    buffer_load_dwordx4 v[160:163], v7, s[36:39], s53 offen sc1
    s_mov_b32 s53, 131072
    buffer_load_dwordx4 v[164:167], v7, s[36:39], s53 offen sc1
    s_waitcnt vmcnt(1)

    v_alignbit_b32 v236, v161, s32, 2
    v_lshl_add_u64 v[162:163], v[162:163], 0, v[228:229]
    v_alignbit_b32 v236, v160, v236, 3
    v_lshl_add_u64 v[160:161], v[160:161], 0, s[30:31]
    v_and_b32 v160, -4, v160
    v_and_b32 v161, -4, v161

    v_or3_b32 v50, v160, v161, v162
    v_or_b32 v50, v50, v163
    v_fma_mix_f32 v240, v160, |v236|, 0 op_sel:[0,0,0] op_sel_hi:[1,0,0]
    v_fma_mix_f32 v241, v160, |v236|, 0 op_sel:[1,0,0] op_sel_hi:[1,0,0]
    v_fma_mix_f32 v242, v161, |v236|, 0 op_sel:[0,0,0] op_sel_hi:[1,0,0]
    v_fma_mix_f32 v243, v161, |v236|, 0 op_sel:[1,0,0] op_sel_hi:[1,0,0]
    v_fma_mix_f32 v244, v162, |v236|, 0 op_sel:[0,0,0] op_sel_hi:[1,0,0]
    v_fma_mix_f32 v245, v162, |v236|, 0 op_sel:[1,0,0] op_sel_hi:[1,0,0]
    v_fma_mix_f32 v246, v163, |v236|, 0 op_sel:[0,0,0] op_sel_hi:[1,0,0]
    v_fma_mix_f32 v247, v163, |v236|, 0 op_sel:[1,0,0] op_sel_hi:[1,0,0]
    s_waitcnt vmcnt(0)

    v_alignbit_b32 v237, v165, s32, 2
    v_lshl_add_u64 v[166:167], v[166:167], 0, v[228:229]
    v_alignbit_b32 v237, v164, v237, 3
    v_lshl_add_u64 v[164:165], v[164:165], 0, s[30:31]
    v_and_b32 v164, -4, v164
    v_and_b32 v165, -4, v165

    v_or3_b32 v50, v50, v164, v165
    v_or3_b32 v50, v50, v166, v167
    v_fma_mix_f32 v240, v164, |v237|, v240 op_sel:[0,0,0] op_sel_hi:[1,0,0]
    v_fma_mix_f32 v241, v164, |v237|, v241 op_sel:[1,0,0] op_sel_hi:[1,0,0]
    v_fma_mix_f32 v242, v165, |v237|, v242 op_sel:[0,0,0] op_sel_hi:[1,0,0]
    v_fma_mix_f32 v243, v165, |v237|, v243 op_sel:[1,0,0] op_sel_hi:[1,0,0]
    v_fma_mix_f32 v244, v166, |v237|, v244 op_sel:[0,0,0] op_sel_hi:[1,0,0]
    v_fma_mix_f32 v245, v166, |v237|, v245 op_sel:[1,0,0] op_sel_hi:[1,0,0]
    v_fma_mix_f32 v246, v167, |v237|, v246 op_sel:[0,0,0] op_sel_hi:[1,0,0]
    v_fma_mix_f32 v247, v167, |v237|, v247 op_sel:[1,0,0] op_sel_hi:[1,0,0]
    v_and_b32 v50, 0x30003, v50
    v_cmp_ne_u32 vcc, 0, v50
    s_cbranch_vccnz L_slow_43
L_ok_45:
    v_permlane16_swap_b32 v240, v244
    v_permlane16_swap_b32 v241, v245
    v_permlane16_swap_b32 v242, v246
    v_permlane16_swap_b32 v243, v247
    v_pk_add_f32 v[240:241], v[240:241], v[244:245]
    v_pk_add_f32 v[242:243], v[242:243], v[246:247]
    v_mul_f32 v240, s54, v240
    v_mul_f32 v241, s54, v241
    v_mul_f32 v242, s54, v242
    v_mul_f32 v243, s54, v243
    v_cvt_pk_bf16_f32 v240, v240, v241
    v_cvt_pk_bf16_f32 v241, v242, v243
    ds_write_b64 v24, v[240:241]
    v_mov_b32 v50, 2
    ds_write_b32 v12, v50

    s_lshl2_add_u32 s67, s2, s56
    s_lshl_b32 s67, s67, 9
    s_add_u32 s67, s67, 1048576
    v_and_b32 v51, 1, v0
    v_cmp_eq_u32 vcc, 0, v51
    v_subrev_u32 v170, 1, v51
    v_lshl_add_u32 v51, v3, 1, v4
    v_lshl_add_u32 v51, v51, 4, s67
    v_cndmask_b32 v14, v63, v51, vcc
    s_xor_b32 s67, s28, 0x20000
    v_bfi_b32 v168, v170, s67, v252
    v_bfi_b32 v169, v170, s29, v253
    s_lshr_b32 s67, s2, 5
    s_lshl_b32 s67, s67, 10
    s_and_b32 s68, s2, 31
    s_or_b32 s67, s67, s68
    s_lshl_b32 s67, s67, 6
    s_add_u32 s67, s67, 1048576
    v_and_b32 v51, 60, v0
    v_and_b32 v50, 3, v0
    v_lshl_add_u32 v51, v51, 5, v50
    v_lshl_add_u32 v13, v51, 4, s67
    v_lshlrev_b32 v50, 16, v18
    v_and_b32 v51, 0xffff0000, v18
    v_lshlrev_b32 v18, 16, v19
    v_and_b32 v19, 0xffff0000, v19
    v_pk_add_f32 v[18:19], v[18:19], v[50:51]

    v_lshlrev_b32 v44, 16, v48
    v_and_b32 v45, 0xffff0000, v48
    v_lshlrev_b32 v46, 16, v49
    v_and_b32 v47, 0xffff0000, v49
L_pw_46:

    ds_read_b32 v50, v11 offset:0
    s_sub_u32 s74, s74, 1
    s_cmp_lt_i32 s74, 0
    s_cbranch_scc1 L_pk_47
    s_waitcnt lgkmcnt(0)
    v_cmp_gt_u32 vcc, 3, v50
    s_cbranch_vccnz L_pw_46

L_pk_47:
    ds_read_b128 v[64:67], v39
    ds_read_b128 v[68:71], v39 offset:16
    ds_read_b128 v[72:75], v25
    ds_read_b128 v[76:79], v25 offset:16
    v_mov_b32 v54, s19
    v_mov_b32 v55, 0
    s_waitcnt lgkmcnt(0)
    v_max3_f32 v52, v64, v66, v68
    v_max_f32 v52, v52, v70
    v_and_b32 v52, v2, v52
    v_sub_f32 v40, v64, v52
    v_sub_f32 v41, v66, v52
    v_sub_f32 v42, v68, v52
    v_sub_f32 v43, v70, v52
    v_exp_f32 v40, v40
    v_exp_f32 v41, v41
    v_exp_f32 v42, v42
    v_exp_f32 v43, v43
    v_mul_f32 v53, v40, v65
    v_fmac_f32 v53, v41, v67
    v_fmac_f32 v53, v42, v69
    v_fmac_f32 v53, v43, v71
    v_and_or_b32 v52, v52, v2, s48
    v_and_or_b32 v53, v53, v2, s49
    v_and_or_b32 v54, v54, v2, s50
    v_and_or_b32 v55, v55, v2, s51
    buffer_store_dwordx4 v[52:55], v16, s[36:39], 0 offen sc1
    v_max3_f32 v56, v72, v74, v76
    v_max_f32 v56, v56, v78
    v_and_b32 v56, v2, v56
    v_sub_f32 v40, v72, v56
    v_sub_f32 v41, v74, v56
    v_sub_f32 v42, v76, v56
    v_sub_f32 v43, v78, v56
    v_exp_f32 v40, v40
    v_exp_f32 v41, v41
    v_exp_f32 v42, v42
    v_exp_f32 v43, v43
    v_mov_b32 v64, v8
    v_mov_b32 v65, v38
    v_mov_b32 v66, v228
    v_mov_b32 v67, v229
    v_mov_b32 v68, 0xff800000
    v_cndmask_b32 v44, v68, v44, s[64:65]
    v_cndmask_b32 v45, v68, v45, s[64:65]
    v_cndmask_b32 v46, v68, v46, s[64:65]
    v_cndmask_b32 v47, v68, v47, s[64:65]

    v_cndmask_b32 v68, 0, -1, s[64:65]
    v_mov_b32 v69, s30
    v_mov_b32 v70, s31
    v_lshl_add_u32 v72, s56, 10, v1
    ds_write_b128 v72, v[64:67] offset:17408
    ds_write_b128 v72, v[44:47] offset:21504
    ds_write_b128 v72, v[68:71] offset:25600

    v_mov_b32 v50, 3
    ds_write_b32 v12, v50
L_pw_48:

    ds_read_b32 v50, v11 offset:0
    s_sub_u32 s74, s74, 1
    s_cmp_lt_i32 s74, 0
    s_cbranch_scc1 L_pk_49
    s_waitcnt lgkmcnt(0)
    v_cmp_gt_u32 vcc, 4, v50
    s_cbranch_vccnz L_pw_48

L_pk_49:
    s_mov_b32 s53, 0
    buffer_load_dwordx4 v[232:235], v10, s[36:39], s53 offen sc1
L_pw_50:

    ds_read_b32 v50, v11 offset:0
    s_sub_u32 s74, s74, 1
    s_cmp_lt_i32 s74, 0
    s_cbranch_scc1 L_pk_51
    s_waitcnt lgkmcnt(0)
    v_cmp_gt_u32 vcc, 5, v50
    s_cbranch_vccnz L_pw_50

L_pk_51:
    s_xor_b32 s67, s5, s18
    v_lshl_add_u32 v22, s67, 9, v22
    ds_read2_b64 v[128:131], v22 offset0:0 offset1:4
    ds_read2_b64 v[132:135], v22 offset0:8 offset1:12
    ds_read2_b64 v[136:139], v22 offset0:16 offset1:20
    ds_read2_b64 v[140:143], v22 offset0:24 offset1:28
    ds_read2_b64 v[144:147], v22 offset0:32 offset1:36
    ds_read2_b64 v[148:151], v22 offset0:40 offset1:44
    ds_read2_b64 v[152:155], v22 offset0:48 offset1:52
    ds_read2_b64 v[156:159], v22 offset0:56 offset1:60

    s_cmp_lg_u32 s56, 3
    s_cbranch_scc1 L_notk_52
    s_lshl_b32 s67, s18, 6
    s_mov_b32 s68, 1

    s_atomic_add s68, s[16:17], s67 glc
    s_mov_b64 exec, 1
    s_waitcnt lgkmcnt(0)
    s_and_b32 s68, s68, 63
    v_mov_b32 v52, s68

    v_subrev_u32 v53, 3, v52
    v_mul_u32_u24 v53, 37, v53
    v_lshrrev_b32 v53, 8, v53
    v_add3_u32 v53, v53, v52, -7
    v_lshl_add_u32 v54, v52, 3, 3
    v_cmp_gt_u32 vcc, 7, v52
    s_nop 1
    v_cndmask_b32 v53, v53, v54, vcc

    v_lshl_add_u32 v53, v52, 8, v53
    ds_write_b32 v11, v53 offset:32
    s_mov_b64 exec, -1

L_notk_52:
    s_waitcnt vmcnt(0)
    v_lshl_add_u64 v[232:233], v[232:233], 0, s[58:59]
    v_lshl_add_u64 v[234:235], v[234:235], 0, s[60:61]
    v_or3_b32 v50, v232, v233, v234
    v_or_b32 v50, v50, v235
    v_cmp_ne_u32_sdwa vcc, 0, v50 src0_sel:DWORD src1_sel:BYTE_0
    s_cbranch_vccnz L_slow_53
L_ok_55:
    v_cmp_ne_u32 s[34:35], s19, v234
    v_mov_b32 v234, v232
    s_nop 1
    v_max_f32_dpp v234, v234, v234 quad_perm:[1,0,3,2] row_mask:0xf bank_mask:0xf
    s_nop 1
    v_max_f32_dpp v234, v234, v234 quad_perm:[2,3,0,1] row_mask:0xf bank_mask:0xf
    s_nop 1
    v_max_f32_dpp v234, v234, v234 row_half_mirror row_mask:0xf bank_mask:0xf
    v_sub_f32 v232, v232, v234
    v_exp_f32 v232, v232
    s_nop 0
    v_mul_f32 v233, v232, v233
    s_nop 1
    v_add_f32_dpp v233, v233, v233 quad_perm:[1,0,3,2] row_mask:0xf bank_mask:0xf
    s_nop 1
    v_add_f32_dpp v233, v233, v233 quad_perm:[2,3,0,1] row_mask:0xf bank_mask:0xf
    s_nop 1
    v_add_f32_dpp v233, v233, v233 row_half_mirror row_mask:0xf bank_mask:0xf

    v_rcp_f32 v233, v233
    s_nop 0
    v_mul_f32 v232, v232, v233
    ds_bpermute_b32 v232, v248, v232
L_gw_56:
    ds_read_b32 v35, v11 offset:32
    s_sub_u32 s74, s74, 1
    s_cmp_lt_i32 s74, 0
    s_waitcnt lgkmcnt(0)
    v_readlane_b32 s67, v35, 0
    s_cbranch_scc1 L_gk_57
    s_cmp_eq_u32 s67, 0
    s_cbranch_scc1 L_gw_56
L_gk_57:
    s_and_b32 s67, s67, 0x700

    v_pk_mul_f32 v[40:41], v[232:233], v[40:41] op_sel:[0,0] op_sel_hi:[0,1]
    v_pk_mul_f32 v[42:43], v[232:233], v[42:43] op_sel:[0,0] op_sel_hi:[0,1]
    v_mov_b32 v224, s28
    v_mov_b32 v225, s29
    s_cmp_lt_u32 s56, 2
    s_cbranch_scc1 L_nrd_59

    v_cmp_gt_u32 vcc, 32, v0
    v_and_b32 v251, 1, v4
    s_nop 0
    v_cndmask_b32 v249, v225, v224, vcc
    v_cndmask_b32 v51, v227, v226, vcc
    v_cndmask_b32 v250, 27, 29, vcc
    v_cmp_eq_u32 vcc, 0, v251
    s_nop 1
    v_cndmask_b32 v249, v51, v249, vcc
    v_cndmask_b32 v251, 0, 2, vcc

    v_mov_b32 v50, 4
    ds_write_b32 v12, v50
L_pw_62:

    ds_read_b32 v50, v11 offset:0
    s_sub_u32 s74, s74, 1
    s_cmp_lt_i32 s74, 0
    s_cbranch_scc1 L_pk_63
    s_waitcnt lgkmcnt(0)
    v_cmp_gt_u32 vcc, 7, v50
    s_cbranch_vccnz L_pw_62

L_pk_63:
L_lt_60:
L_pw_64:

    ds_read_b32 v50, v11 offset:16
    s_sub_u32 s74, s74, 1
    s_cmp_lt_i32 s74, 0
    s_cbranch_scc1 L_pk_65
    s_waitcnt lgkmcnt(0)
    v_cmp_gt_u32 vcc, 4, v50
    s_cbranch_vccnz L_pw_64

L_pk_65:
    buffer_load_dwordx4 v[128:131], v17, s[36:39], 0 offen sc1
    s_mov_b32 s70, 200000
    s_mov_b64 s[8:9], -1
L_pw_68:

    ds_read_b32 v50, v11 offset:0
    s_sub_u32 s74, s74, 1
    s_cmp_lt_i32 s74, 0
    s_cbranch_scc1 L_pk_69
    s_waitcnt lgkmcnt(0)
    v_cmp_gt_u32 vcc, 8, v50
    s_cbranch_vccnz L_pw_68

L_pk_69:
    buffer_load_dwordx4 v[132:135], v17, s[36:39], 0 offen sc1
L_pw_70:

    ds_read_b32 v50, v11 offset:0
    s_sub_u32 s74, s74, 1
    s_cmp_lt_i32 s74, 0
    s_cbranch_scc1 L_pk_71
    s_waitcnt lgkmcnt(0)
    v_cmp_gt_u32 vcc, 9, v50
    s_cbranch_vccnz L_pw_70

L_pk_71:
    buffer_load_dwordx4 v[136:139], v17, s[36:39], 0 offen sc1
L_pw_72:

    ds_read_b32 v50, v11 offset:0
    s_sub_u32 s74, s74, 1
    s_cmp_lt_i32 s74, 0
    s_cbranch_scc1 L_pk_73
    s_waitcnt lgkmcnt(0)
    v_cmp_gt_u32 vcc, 10, v50
    s_cbranch_vccnz L_pw_72

L_pk_73:
    buffer_load_dwordx4 v[140:143], v17, s[36:39], 0 offen sc1
L_pg_66:
    s_mov_b64 exec, s[8:9]
    s_waitcnt vmcnt(3)

    v_lshl_add_u64 v[160:161], v[128:129], 0, s[30:31]
    v_lshl_add_u64 v[162:163], v[130:131], 0, v[228:229]
    v_and_b32 v160, -4, v160
    v_and_b32 v161, -4, v161
    v_or3_b32 v50, v160, v161, v162
    v_or_b32 v50, v50, v163
    v_and_b32 v50, 0x30003, v50
    v_alignbit_b32 v236, v129, s32, 2
    v_alignbit_b32 v236, v128, v236, 3

    v_or_b32_dpp v50, v50, v50 quad_perm:[1,0,3,2] row_mask:0xf bank_mask:0xf
    s_nop 1
    v_or_b32_dpp v50, v50, v50 quad_perm:[2,3,0,1] row_mask:0xf bank_mask:0xf
    v_cmp_ne_u32 s[8:9], 0, v50
    s_or_b64 s[6:7], s[8:9], s[8:9]
    s_cbranch_scc0 L_pe_67
    s_or_b64 exec, s[8:9], 1
    buffer_load_dwordx4 v[128:131], v17, s[36:39], 0 offen sc1
    s_mov_b64 exec, s[8:9]
    s_waitcnt vmcnt(3)

    v_lshl_add_u64 v[160:161], v[132:133], 0, s[30:31]
    v_lshl_add_u64 v[162:163], v[134:135], 0, v[228:229]
    v_and_b32 v160, -4, v160
    v_and_b32 v161, -4, v161
    v_or3_b32 v50, v160, v161, v162
    v_or_b32 v50, v50, v163
    v_and_b32 v50, 0x30003, v50
    v_alignbit_b32 v236, v133, s32, 2
    v_alignbit_b32 v236, v132, v236, 3

    v_or_b32_dpp v50, v50, v50 quad_perm:[1,0,3,2] row_mask:0xf bank_mask:0xf
    s_nop 1
    v_or_b32_dpp v50, v50, v50 quad_perm:[2,3,0,1] row_mask:0xf bank_mask:0xf
    v_cmp_ne_u32 s[8:9], 0, v50
    s_or_b64 s[6:7], s[8:9], s[8:9]
    s_cbranch_scc0 L_pe_67
    s_or_b64 exec, s[8:9], 1
    buffer_load_dwordx4 v[132:135], v17, s[36:39], 0 offen sc1
    s_mov_b64 exec, s[8:9]
    s_waitcnt vmcnt(3)

    v_lshl_add_u64 v[160:161], v[136:137], 0, s[30:31]
    v_lshl_add_u64 v[162:163], v[138:139], 0, v[228:229]
    v_and_b32 v160, -4, v160
    v_and_b32 v161, -4, v161
    v_or3_b32 v50, v160, v161, v162
    v_or_b32 v50, v50, v163
    v_and_b32 v50, 0x30003, v50
    v_alignbit_b32 v236, v137, s32, 2
    v_alignbit_b32 v236, v136, v236, 3

    v_or_b32_dpp v50, v50, v50 quad_perm:[1,0,3,2] row_mask:0xf bank_mask:0xf
    s_nop 1
    v_or_b32_dpp v50, v50, v50 quad_perm:[2,3,0,1] row_mask:0xf bank_mask:0xf
    v_cmp_ne_u32 s[8:9], 0, v50
    s_or_b64 s[6:7], s[8:9], s[8:9]
    s_cbranch_scc0 L_pe_67
    s_or_b64 exec, s[8:9], 1
    buffer_load_dwordx4 v[136:139], v17, s[36:39], 0 offen sc1
    s_mov_b64 exec, s[8:9]
    s_waitcnt vmcnt(3)

    v_lshl_add_u64 v[160:161], v[140:141], 0, s[30:31]
    v_lshl_add_u64 v[162:163], v[142:143], 0, v[228:229]
    v_and_b32 v160, -4, v160
    v_and_b32 v161, -4, v161
    v_or3_b32 v50, v160, v161, v162
    v_or_b32 v50, v50, v163
    v_and_b32 v50, 0x30003, v50
    v_alignbit_b32 v236, v141, s32, 2
    v_alignbit_b32 v236, v140, v236, 3

    v_or_b32_dpp v50, v50, v50 quad_perm:[1,0,3,2] row_mask:0xf bank_mask:0xf
    s_nop 1
    v_or_b32_dpp v50, v50, v50 quad_perm:[2,3,0,1] row_mask:0xf bank_mask:0xf
    v_cmp_ne_u32 s[8:9], 0, v50
    s_or_b64 s[6:7], s[8:9], s[8:9]
    s_cbranch_scc0 L_pe_67
    s_or_b64 exec, s[8:9], 1
    buffer_load_dwordx4 v[140:143], v17, s[36:39], 0 offen sc1
    s_sub_u32 s70, s70, 1
    s_cbranch_scc0 L_pg_66
L_pe_67:
    s_mov_b64 exec, -1
    v_fma_mix_f32 v240, v160, |v236|, 0 op_sel:[0,0,0] op_sel_hi:[1,0,0]
    v_fma_mix_f32 v241, v160, |v236|, 0 op_sel:[1,0,0] op_sel_hi:[1,0,0]
    v_fma_mix_f32 v242, v161, |v236|, 0 op_sel:[0,0,0] op_sel_hi:[1,0,0]
    v_fma_mix_f32 v243, v161, |v236|, 0 op_sel:[1,0,0] op_sel_hi:[1,0,0]
    v_fma_mix_f32 v244, v162, |v236|, 0 op_sel:[0,0,0] op_sel_hi:[1,0,0]
    v_fma_mix_f32 v245, v162, |v236|, 0 op_sel:[1,0,0] op_sel_hi:[1,0,0]
    v_fma_mix_f32 v246, v163, |v236|, 0 op_sel:[0,0,0] op_sel_hi:[1,0,0]
    v_fma_mix_f32 v247, v163, |v236|, 0 op_sel:[1,0,0] op_sel_hi:[1,0,0]
    v_permlane16_swap_b32 v240, v244
    v_permlane16_swap_b32 v241, v245
    v_permlane16_swap_b32 v242, v246
    v_permlane16_swap_b32 v243, v247
    v_pk_add_f32 v[240:241], v[240:241], v[244:245]
    v_pk_add_f32 v[242:243], v[242:243], v[246:247]
    s_nop 1
    v_permlane32_swap_b32 v240, v242
    v_permlane32_swap_b32 v241, v243
    v_pk_add_f32 v[240:241], v[240:241], v[242:243]
    s_nop 1
    v_add_f32_dpp v240, v240, v240 row_ror:8 row_mask:0xf bank_mask:0xf
    v_add_f32_dpp v241, v241, v241 row_ror:8 row_mask:0xf bank_mask:0xf
    v_max_f32 v50, |v240|, |v241|
    v_mov_b32 v51, v50
    s_nop 1
    v_permlane16_swap_b32 v50, v51
    v_max_f32 v50, v50, v51
    v_mov_b32 v51, v50
    s_nop 1
    v_permlane32_swap_b32 v50, v51
    v_max_f32 v50, v50, v51

    v_and_b32 v50, 0x78000000, v50
    v_sub_u32 v51, 0x7e802c00, v50
    v_bfe_u32 v50, v50, v250, v251
    v_mul_f32 v240, v240, v51
    v_mul_f32 v241, v241, v51
    v_or_b32 v50, v50, v249
    v_cvt_pkrtz_f16_f32 v240, v240, v241
    v_and_or_b32 v240, v240, s33, v50
    s_nop 1
    v_permlane32_swap_b32 v240, v241
    s_nop 1
    v_permlane16_swap_b32 v240, v242
    v_permlane16_swap_b32 v241, v243

    buffer_store_dwordx4 v[240:243], v231, s[36:39], 0 offen sc1
    s_branch L_rdf_61
L_nrd_59:
L_pw_74:

    ds_read_b32 v50, v11 offset:0
    s_sub_u32 s74, s74, 1
    s_cmp_lt_i32 s74, 0
    s_cbranch_scc1 L_pk_75
    s_waitcnt lgkmcnt(0)
    v_cmp_gt_u32 vcc, 6, v50
    s_cbranch_vccnz L_pw_74

L_pk_75:
    ds_read_b128 v[64:67], v26 offset:0
    ds_read_b128 v[68:71], v26 offset:16
    ds_read_b128 v[72:75], v26 offset:4224
    ds_read_b128 v[76:79], v26 offset:4240
    ds_read_b128 v[80:83], v26 offset:8448
    ds_read_b128 v[84:87], v26 offset:8464
    ds_read_b128 v[88:91], v26 offset:12672
    ds_read_b128 v[92:95], v26 offset:12688
    s_cmp_eq_u64 s[34:35], 0
    s_waitcnt lgkmcnt(7)
    v_pk_mul_f32 v[52:53], v[40:41], v[64:65] op_sel:[0,0] op_sel_hi:[0,1]
    v_pk_mul_f32 v[54:55], v[40:41], v[66:67] op_sel:[0,0] op_sel_hi:[0,1]
    s_waitcnt lgkmcnt(6)
    v_pk_mul_f32 v[56:57], v[40:41], v[68:69] op_sel:[0,0] op_sel_hi:[0,1]
    v_pk_mul_f32 v[58:59], v[40:41], v[70:71] op_sel:[0,0] op_sel_hi:[0,1]
    s_waitcnt lgkmcnt(5)
    v_pk_fma_f32 v[52:53], v[40:41], v[72:73], v[52:53] op_sel:[1,0,0] op_sel_hi:[1,1,1]
    v_pk_fma_f32 v[54:55], v[40:41], v[74:75], v[54:55] op_sel:[1,0,0] op_sel_hi:[1,1,1]
    s_waitcnt lgkmcnt(4)
    v_pk_fma_f32 v[56:57], v[40:41], v[76:77], v[56:57] op_sel:[1,0,0] op_sel_hi:[1,1,1]
    v_pk_fma_f32 v[58:59], v[40:41], v[78:79], v[58:59] op_sel:[1,0,0] op_sel_hi:[1,1,1]
    s_waitcnt lgkmcnt(3)
    v_pk_fma_f32 v[52:53], v[42:43], v[80:81], v[52:53] op_sel:[0,0,0] op_sel_hi:[0,1,1]
    v_pk_fma_f32 v[54:55], v[42:43], v[82:83], v[54:55] op_sel:[0,0,0] op_sel_hi:[0,1,1]
    s_waitcnt lgkmcnt(2)
    v_pk_fma_f32 v[56:57], v[42:43], v[84:85], v[56:57] op_sel:[0,0,0] op_sel_hi:[0,1,1]
    v_pk_fma_f32 v[58:59], v[42:43], v[86:87], v[58:59] op_sel:[0,0,0] op_sel_hi:[0,1,1]
    s_waitcnt lgkmcnt(1)
    v_pk_fma_f32 v[52:53], v[42:43], v[88:89], v[52:53] op_sel:[1,0,0] op_sel_hi:[1,1,1]
    v_pk_fma_f32 v[54:55], v[42:43], v[90:91], v[54:55] op_sel:[1,0,0] op_sel_hi:[1,1,1]
    s_waitcnt lgkmcnt(0)
    v_pk_fma_f32 v[56:57], v[42:43], v[92:93], v[56:57] op_sel:[1,0,0] op_sel_hi:[1,1,1]
    v_pk_fma_f32 v[58:59], v[42:43], v[94:95], v[58:59] op_sel:[1,0,0] op_sel_hi:[1,1,1]
    v_max3_f32 v50, |v52|, |v53|, |v54|
    v_max3_f32 v50, v50, |v55|, |v56|
    v_max3_f32 v50, v50, |v57|, |v58|
    v_max_f32 v50, v50, |v59|
    v_and_b32 v50, 0x78000000, v50
    v_sub_u32 v51, 0x7e802c00, v50
    v_pk_mul_f32 v[52:53], v[50:51], v[52:53] op_sel:[1,0] op_sel_hi:[1,1]
    v_pk_mul_f32 v[54:55], v[50:51], v[54:55] op_sel:[1,0] op_sel_hi:[1,1]
    v_pk_mul_f32 v[56:57], v[50:51], v[56:57] op_sel:[1,0] op_sel_hi:[1,1]
    v_pk_mul_f32 v[58:59], v[50:51], v[58:59] op_sel:[1,0] op_sel_hi:[1,1]
    v_bfe_u32 v51, v50, 27, 2
    v_lshrrev_b32 v50, 29, v50
    v_cvt_pkrtz_f16_f32 v52, v52, v53
    v_cvt_pkrtz_f16_f32 v53, v54, v55
    v_cvt_pkrtz_f16_f32 v54, v56, v57
    v_cvt_pkrtz_f16_f32 v55, v58, v59
    v_or_b32 v50, s28, v50
    v_or_b32 v51, s29, v51
    v_and_or_b32 v52, v52, s33, v50
    v_and_or_b32 v53, v53, s33, v51
    v_and_or_b32 v54, v54, s33, v226
    v_and_or_b32 v55, v55, s33, v227
    s_cbranch_scc0 L_far_76
    buffer_store_dwordx4 v[52:55], v15, s[36:39], 0 offen
L_back_77:
    v_mov_b32 v50, 4
    ds_write_b32 v12, v50
L_rdf_61:

    v_readfirstlane_b32 s67, v35
    s_and_b32 s67, s67, 127
    s_max_u32 s55, s55, s67
    s_lshl_b32 s67, s67, 10
    s_cmp_lt_u32 s55, 56
    s_cselect_b32 s67, s67, 0x40000000
    v_add_u32 v6, s67, v6

    s_cmp_ge_u32 s55, 56
    s_cbranch_scc1 L_skh_78
L_pw_79:

    ds_read_b32 v50, v11 offset:0
    s_sub_u32 s74, s74, 1
    s_cmp_lt_i32 s74, 0
    s_cbranch_scc1 L_pk_80
    s_waitcnt lgkmcnt(0)
    v_cmp_gt_u32 vcc, 10, v50
    s_cbranch_vccnz L_pw_79

L_pk_80:
    ds_read_b64_tr_b16 v[64:65], v21 offset:32768
    ds_read_b64_tr_b16 v[66:67], v21 offset:34816
    ds_read_b64_tr_b16 v[68:69], v37 offset:32768
    ds_read_b64_tr_b16 v[70:71], v37 offset:34816
    ds_read_b64_tr_b16 v[72:73], v21 offset:36864
    ds_read_b64_tr_b16 v[74:75], v21 offset:38912
    ds_read_b64_tr_b16 v[76:77], v37 offset:36864
    ds_read_b64_tr_b16 v[78:79], v37 offset:38912
    ds_read_b64_tr_b16 v[80:81], v21 offset:40960
    ds_read_b64_tr_b16 v[82:83], v21 offset:43008
    ds_read_b64_tr_b16 v[84:85], v37 offset:40960
    ds_read_b64_tr_b16 v[86:87], v37 offset:43008
    s_waitcnt lgkmcnt(10)
    v_mfma_f32_16x16x32_bf16 v[52:55], v[64:67], v[128:131], 0
    s_waitcnt lgkmcnt(8)
    v_mfma_f32_16x16x32_bf16 v[56:59], v[68:71], v[128:131], 0
    ds_read_b64_tr_b16 v[88:89], v21 offset:45056
    ds_read_b64_tr_b16 v[90:91], v21 offset:47104
    ds_read_b64_tr_b16 v[92:93], v37 offset:45056
    ds_read_b64_tr_b16 v[94:95], v37 offset:47104
    s_waitcnt lgkmcnt(10)
    v_mfma_f32_16x16x32_bf16 v[52:55], v[72:75], v[132:135], v[52:55]
    s_waitcnt lgkmcnt(8)
    v_mfma_f32_16x16x32_bf16 v[56:59], v[76:79], v[132:135], v[56:59]
    ds_read_b64_tr_b16 v[96:97], v21 offset:49152
    ds_read_b64_tr_b16 v[98:99], v21 offset:51200
    ds_read_b64_tr_b16 v[100:101], v37 offset:49152
    ds_read_b64_tr_b16 v[102:103], v37 offset:51200
    s_waitcnt lgkmcnt(10)
    v_mfma_f32_16x16x32_bf16 v[52:55], v[80:83], v[136:139], v[52:55]
    s_waitcnt lgkmcnt(8)
    v_mfma_f32_16x16x32_bf16 v[56:59], v[84:87], v[136:139], v[56:59]
    ds_read_b64_tr_b16 v[104:105], v21 offset:53248
    ds_read_b64_tr_b16 v[106:107], v21 offset:55296
    ds_read_b64_tr_b16 v[108:109], v37 offset:53248
    ds_read_b64_tr_b16 v[110:111], v37 offset:55296
    s_waitcnt lgkmcnt(10)
    v_mfma_f32_16x16x32_bf16 v[52:55], v[88:91], v[140:143], v[52:55]
    s_waitcnt lgkmcnt(8)
    v_mfma_f32_16x16x32_bf16 v[56:59], v[92:95], v[140:143], v[56:59]
    s_waitcnt lgkmcnt(6)
    v_mfma_f32_16x16x32_bf16 v[52:55], v[96:99], v[144:147], v[52:55]
    s_waitcnt lgkmcnt(4)
    v_mfma_f32_16x16x32_bf16 v[56:59], v[100:103], v[144:147], v[56:59]
    s_waitcnt lgkmcnt(2)
    v_mfma_f32_16x16x32_bf16 v[52:55], v[104:107], v[148:151], v[52:55]
    s_waitcnt lgkmcnt(0)
    v_mfma_f32_16x16x32_bf16 v[56:59], v[108:111], v[148:151], v[56:59]
L_pw_81:

    ds_read_b32 v50, v11 offset:0
    s_sub_u32 s74, s74, 1
    s_cmp_lt_i32 s74, 0
    s_cbranch_scc1 L_pk_82
    s_waitcnt lgkmcnt(0)
    v_cmp_gt_u32 vcc, 11, v50
    s_cbranch_vccnz L_pw_81

L_pk_82:
    ds_read_b64_tr_b16 v[112:113], v21 offset:57344
    ds_read_b64_tr_b16 v[114:115], v21 offset:59392
    ds_read_b64_tr_b16 v[116:117], v37 offset:57344
    ds_read_b64_tr_b16 v[118:119], v37 offset:59392
    ds_read_b64_tr_b16 v[120:121], v21 offset:61440
    ds_read_b64_tr_b16 v[122:123], v21 offset:63488
    ds_read_b64_tr_b16 v[124:125], v37 offset:61440
    ds_read_b64_tr_b16 v[126:127], v37 offset:63488
    s_waitcnt lgkmcnt(6)
    v_mfma_f32_16x16x32_bf16 v[52:55], v[112:115], v[152:155], v[52:55]
    s_waitcnt lgkmcnt(4)
    v_mfma_f32_16x16x32_bf16 v[56:59], v[116:119], v[152:155], v[56:59]
    s_waitcnt lgkmcnt(2)
    v_mfma_f32_16x16x32_bf16 v[52:55], v[120:123], v[156:159], v[52:55]
    s_waitcnt lgkmcnt(0)
    v_mfma_f32_16x16x32_bf16 v[56:59], v[124:127], v[156:159], v[56:59]
    s_nop 5
    v_max3_f32 v50, |v52|, |v53|, |v54|
    s_nop 0
    v_max3_f32 v50, v50, |v55|, |v56|
    v_max3_f32 v50, v50, |v57|, |v58|
    v_max_f32 v50, v50, |v59|
    v_and_b32 v50, 0x78000000, v50
    v_sub_u32 v51, 0x7e802c00, v50
    v_pk_mul_f32 v[52:53], v[50:51], v[52:53] op_sel:[1,0] op_sel_hi:[1,1]
    v_pk_mul_f32 v[54:55], v[50:51], v[54:55] op_sel:[1,0] op_sel_hi:[1,1]
    v_pk_mul_f32 v[56:57], v[50:51], v[56:57] op_sel:[1,0] op_sel_hi:[1,1]
    v_pk_mul_f32 v[58:59], v[50:51], v[58:59] op_sel:[1,0] op_sel_hi:[1,1]
    v_bfe_u32 v51, v50, 27, 2
    v_lshrrev_b32 v50, 29, v50
    v_cvt_pkrtz_f16_f32 v52, v52, v53
    v_cvt_pkrtz_f16_f32 v53, v54, v55
    v_cvt_pkrtz_f16_f32 v54, v56, v57
    v_cvt_pkrtz_f16_f32 v55, v58, v59
    v_or_b32 v50, s28, v50
    v_or_b32 v51, s29, v51
    v_and_or_b32 v52, v52, s33, v50
    v_and_or_b32 v53, v53, s33, v51
    v_and_or_b32 v54, v54, s33, v252
    v_and_or_b32 v55, v55, s33, v253
L_skh_78:
    buffer_store_dwordx4 v[52:55], v6, s[36:39], 0 offen sc1
L_pw_83:

    ds_read_b32 v50, v11 offset:0
    s_sub_u32 s74, s74, 1
    s_cmp_lt_i32 s74, 0
    s_cbranch_scc1 L_pk_84
    s_waitcnt lgkmcnt(0)
    v_cmp_gt_u32 vcc, 12, v50
    s_cbranch_vccnz L_pw_83

L_pk_84:
    s_mov_b32 s53, 0
    buffer_load_dwordx4 v[160:163], v9, s[36:39], s53 offen sc1
    ds_read_b64_tr_b16 v[64:65], v29 offset:0
    ds_read_b64_tr_b16 v[66:67], v29 offset:256
    ds_read_b64_tr_b16 v[68:69], v30 offset:0
    ds_read_b64_tr_b16 v[70:71], v30 offset:256
    ds_read_b64_tr_b16 v[72:73], v29 offset:8192
    ds_read_b64_tr_b16 v[74:75], v29 offset:8448
    ds_read_b64_tr_b16 v[76:77], v30 offset:8192
    ds_read_b64_tr_b16 v[78:79], v30 offset:8448
    ds_read_b64_tr_b16 v[80:81], v29 offset:16384
    ds_read_b64_tr_b16 v[82:83], v29 offset:16640
    ds_read_b64_tr_b16 v[84:85], v30 offset:16384
    ds_read_b64_tr_b16 v[86:87], v30 offset:16640
L_pw_85:

    ds_read_b32 v50, v11 offset:0
    s_sub_u32 s74, s74, 1
    s_cmp_lt_i32 s74, 0
    s_cbranch_scc1 L_pk_86
    s_waitcnt lgkmcnt(0)
    v_cmp_gt_u32 vcc, 13, v50
    s_cbranch_vccnz L_pw_85

L_pk_86:
    ds_read_b64_tr_b16 v[96:97], v31 offset:0
    ds_read_b64_tr_b16 v[98:99], v31 offset:1024
    ds_read_b64_tr_b16 v[100:101], v32 offset:0
    ds_read_b64_tr_b16 v[102:103], v32 offset:1024
    ds_read_b64_tr_b16 v[104:105], v31 offset:8192
    ds_read_b64_tr_b16 v[106:107], v31 offset:9216
    ds_read_b64_tr_b16 v[108:109], v32 offset:8192
    ds_read_b64_tr_b16 v[110:111], v32 offset:9216
    ds_read_b64_tr_b16 v[112:113], v31 offset:16384
    ds_read_b64_tr_b16 v[114:115], v31 offset:17408
    ds_read_b64_tr_b16 v[116:117], v32 offset:16384
    ds_read_b64_tr_b16 v[118:119], v32 offset:17408
L_pw_87:

    ds_read_b32 v50, v11 offset:0
    s_sub_u32 s74, s74, 1
    s_cmp_lt_i32 s74, 0
    s_cbranch_scc1 L_pk_88
    s_waitcnt lgkmcnt(0)
    v_cmp_gt_u32 vcc, 14, v50
    s_cbranch_vccnz L_pw_87

L_pk_88:
    ds_read_b64_tr_b16 v[88:89], v29 offset:24576
    ds_read_b64_tr_b16 v[90:91], v29 offset:24832
    ds_read_b64_tr_b16 v[92:93], v30 offset:24576
    ds_read_b64_tr_b16 v[94:95], v30 offset:24832
L_pw_89:

    ds_read_b32 v50, v11 offset:0
    s_sub_u32 s74, s74, 1
    s_cmp_lt_i32 s74, 0
    s_cbranch_scc1 L_pk_90
    s_waitcnt lgkmcnt(0)
    v_cmp_gt_u32 vcc, 15, v50
    s_cbranch_vccnz L_pw_89

L_pk_90:
    ds_read_b64_tr_b16 v[120:121], v33 offset:24576
    ds_read_b64_tr_b16 v[122:123], v33 offset:25600
    ds_read_b64_tr_b16 v[124:125], v34 offset:24576
    ds_read_b64_tr_b16 v[126:127], v34 offset:25600
    s_mov_b32 s40, 0xffff0000
    s_mov_b32 s41, s40
    s_waitcnt vmcnt(0)

    v_alignbit_b32 v236, v161, s32, 2
    v_lshl_add_u64 v[162:163], v[162:163], 0, v[228:229]
    v_alignbit_b32 v236, v160, v236, 3
    v_lshl_add_u64 v[160:161], v[160:161], 0, s[30:31]
    v_and_b32 v160, -4, v160
    v_and_b32 v161, -4, v161

    v_or3_b32 v50, v160, v161, v162
    v_or_b32 v50, v50, v163
    v_cndmask_b32 v244, v160, v162, s[40:41]
    v_cndmask_b32 v245, v161, v163, s[40:41]
    v_fma_mix_f32 v240, v244, |v236|, 0 op_sel:[0,0,0] op_sel_hi:[1,0,0]
    v_fma_mix_f32 v241, v244, |v236|, 0 op_sel:[1,0,0] op_sel_hi:[1,0,0]
    v_fma_mix_f32 v242, v245, |v236|, 0 op_sel:[0,0,0] op_sel_hi:[1,0,0]
    v_fma_mix_f32 v243, v245, |v236|, 0 op_sel:[1,0,0] op_sel_hi:[1,0,0]
    v_and_b32 v50, 0x30003, v50
    v_cmp_ne_u32 vcc, 0, v50
    s_cbranch_vccnz L_slow_91
L_ok_93:
    v_cvt_pk_bf16_f32 v240, v240, v241
    v_cvt_pk_bf16_f32 v241, v242, v243
    ds_write_b64 v27, v[240:241]
    s_waitcnt lgkmcnt(0)
    s_barrier
    ds_read_b128 v[176:179], v28 offset:0
    ds_read_b128 v[180:183], v28 offset:64
    ds_read_b128 v[184:187], v28 offset:128
    ds_read_b128 v[188:191], v28 offset:192
    s_waitcnt lgkmcnt(3)
    v_mfma_f32_16x16x32_bf16 v[192:195], v[64:67], v[176:179], 0
    v_mfma_f32_16x16x32_bf16 v[196:199], v[68:71], v[176:179], 0
    v_mfma_f32_16x16x32_bf16 v[200:203], v[96:99], v[176:179], 0
    v_mfma_f32_16x16x32_bf16 v[204:207], v[100:103], v[176:179], 0
    s_waitcnt lgkmcnt(2)
    v_mfma_f32_16x16x32_bf16 v[192:195], v[72:75], v[180:183], v[192:195]
    v_mfma_f32_16x16x32_bf16 v[196:199], v[76:79], v[180:183], v[196:199]
    v_mfma_f32_16x16x32_bf16 v[200:203], v[104:107], v[180:183], v[200:203]
    v_mfma_f32_16x16x32_bf16 v[204:207], v[108:111], v[180:183], v[204:207]
    s_waitcnt lgkmcnt(1)
    v_mfma_f32_16x16x32_bf16 v[192:195], v[80:83], v[184:187], v[192:195]
    v_mfma_f32_16x16x32_bf16 v[196:199], v[84:87], v[184:187], v[196:199]
    v_mfma_f32_16x16x32_bf16 v[200:203], v[112:115], v[184:187], v[200:203]
    v_mfma_f32_16x16x32_bf16 v[204:207], v[116:119], v[184:187], v[204:207]
    s_waitcnt lgkmcnt(0)
    v_mfma_f32_16x16x32_bf16 v[192:195], v[88:91], v[188:191], v[192:195]
    v_mfma_f32_16x16x32_bf16 v[196:199], v[92:95], v[188:191], v[196:199]
    v_mfma_f32_16x16x32_bf16 v[200:203], v[120:123], v[188:191], v[200:203]
    v_mfma_f32_16x16x32_bf16 v[204:207], v[124:127], v[188:191], v[204:207]
    s_cmp_eq_u64 s[34:35], 0
    s_nop 5
    v_add_f32_dpp v52, v200, v192 row_ror:8 row_mask:0xf bank_mask:0x3
    v_add_f32_dpp v53, v201, v193 row_ror:8 row_mask:0xf bank_mask:0x3
    v_add_f32_dpp v54, v202, v194 row_ror:8 row_mask:0xf bank_mask:0x3
    v_add_f32_dpp v55, v203, v195 row_ror:8 row_mask:0xf bank_mask:0x3
    v_add_f32_dpp v52, v196, v204 row_ror:8 row_mask:0xf bank_mask:0xc
    v_add_f32_dpp v53, v197, v205 row_ror:8 row_mask:0xf bank_mask:0xc
    v_add_f32_dpp v54, v198, v206 row_ror:8 row_mask:0xf bank_mask:0xc
    v_add_f32_dpp v55, v199, v207 row_ror:8 row_mask:0xf bank_mask:0xc
    v_max3_f32 v50, |v52|, |v53|, |v54|
    v_max_f32 v50, v50, |v55|
    s_nop 1
    v_max_f32_dpp v50, v50, v50 quad_perm:[1,0,3,2] row_mask:0xf bank_mask:0xf
    v_and_b32 v50, 0x78000000, v50
    v_sub_u32 v51, 0x7e802c00, v50
    v_pk_mul_f32 v[52:53], v[50:51], v[52:53] op_sel:[1,0] op_sel_hi:[1,1]
    v_pk_mul_f32 v[54:55], v[50:51], v[54:55] op_sel:[1,0] op_sel_hi:[1,1]
    v_and_b32 v50, v50, v170
    v_bfe_u32 v51, v50, 27, 2
    v_lshrrev_b32 v50, 29, v50
    v_cvt_pkrtz_f16_f32 v52, v52, v53
    v_cvt_pkrtz_f16_f32 v53, v54, v55
    v_or_b32 v50, v168, v50
    v_or_b32 v51, v169, v51
    v_and_or_b32 v52, v52, s33, v50
    v_and_or_b32 v53, v53, s33, v51
    s_nop 0
    v_mov_b32_dpp v54, v52 quad_perm:[1,1,3,3] row_mask:0xf bank_mask:0xf
    v_mov_b32_dpp v55, v53 quad_perm:[1,1,3,3] row_mask:0xf bank_mask:0xf
    s_cbranch_scc0 L_far_94
    buffer_store_dwordx4 v[52:55], v14, s[36:39], 0 offen
L_back_95:
    s_cmp_gt_u32 s3, 4
    s_cbranch_scc1 L_fin
    s_mov_b32 s53, 0
    buffer_load_dwordx4 v[160:163], v13, s[36:39], s53 offen sc1
    s_mov_b32 s53, 32768
    buffer_load_dwordx4 v[164:167], v13, s[36:39], s53 offen sc1
    s_xor_b32 s28, s28, 0x20000
    s_sub_u32 s30, 0, s28
    s_subb_u32 s31, 0, s29
    s_mov_b32 s70, 200000
L_chk_97:
    s_waitcnt vmcnt(1)

    v_alignbit_b32 v236, v161, s32, 2
    v_lshl_add_u64 v[162:163], v[162:163], 0, v[228:229]
    v_alignbit_b32 v236, v160, v236, 3
    v_lshl_add_u64 v[160:161], v[160:161], 0, s[30:31]
    v_and_b32 v160, -4, v160
    v_and_b32 v161, -4, v161

    v_or3_b32 v50, v160, v161, v162
    v_or_b32 v50, v50, v163
    v_fma_mix_f32 v240, v160, |v236|, 0 op_sel:[0,0,0] op_sel_hi:[1,0,0]
    v_fma_mix_f32 v241, v160, |v236|, 0 op_sel:[1,0,0] op_sel_hi:[1,0,0]
    v_fma_mix_f32 v242, v161, |v236|, 0 op_sel:[0,0,0] op_sel_hi:[1,0,0]
    v_fma_mix_f32 v243, v161, |v236|, 0 op_sel:[1,0,0] op_sel_hi:[1,0,0]
    v_fma_mix_f32 v244, v162, |v236|, 0 op_sel:[0,0,0] op_sel_hi:[1,0,0]
    v_fma_mix_f32 v245, v162, |v236|, 0 op_sel:[1,0,0] op_sel_hi:[1,0,0]
    v_fma_mix_f32 v246, v163, |v236|, 0 op_sel:[0,0,0] op_sel_hi:[1,0,0]
    v_fma_mix_f32 v247, v163, |v236|, 0 op_sel:[1,0,0] op_sel_hi:[1,0,0]
    s_waitcnt vmcnt(0)

    v_alignbit_b32 v237, v165, s32, 2
    v_lshl_add_u64 v[166:167], v[166:167], 0, v[228:229]
    v_alignbit_b32 v237, v164, v237, 3
    v_lshl_add_u64 v[164:165], v[164:165], 0, s[30:31]
    v_and_b32 v164, -4, v164
    v_and_b32 v165, -4, v165

    v_or3_b32 v50, v50, v164, v165
    v_or3_b32 v50, v50, v166, v167
    v_fma_mix_f32 v240, v164, |v237|, v240 op_sel:[0,0,0] op_sel_hi:[1,0,0]
    v_fma_mix_f32 v241, v164, |v237|, v241 op_sel:[1,0,0] op_sel_hi:[1,0,0]
    v_fma_mix_f32 v242, v165, |v237|, v242 op_sel:[0,0,0] op_sel_hi:[1,0,0]
    v_fma_mix_f32 v243, v165, |v237|, v243 op_sel:[1,0,0] op_sel_hi:[1,0,0]
    v_fma_mix_f32 v244, v166, |v237|, v244 op_sel:[0,0,0] op_sel_hi:[1,0,0]
    v_fma_mix_f32 v245, v166, |v237|, v245 op_sel:[1,0,0] op_sel_hi:[1,0,0]
    v_fma_mix_f32 v246, v167, |v237|, v246 op_sel:[0,0,0] op_sel_hi:[1,0,0]
    v_fma_mix_f32 v247, v167, |v237|, v247 op_sel:[1,0,0] op_sel_hi:[1,0,0]
    v_and_b32 v50, 0x30003, v50
    v_cmp_ne_u32 vcc, 0, v50
    s_cbranch_vccnz L_slow_96
L_ok_98:
    s_mov_b64 exec, -1
    v_permlane16_swap_b32 v240, v244
    v_permlane16_swap_b32 v241, v245
    v_permlane16_swap_b32 v242, v246
    v_permlane16_swap_b32 v243, v247
    v_pk_add_f32 v[240:241], v[240:241], v[244:245]
    v_pk_add_f32 v[242:243], v[242:243], v[246:247]
    s_nop 1
    v_permlane32_swap_b32 v240, v242
    v_permlane32_swap_b32 v241, v243
    v_pk_add_f32 v[240:241], v[240:241], v[242:243]
    s_nop 1
    v_add_f32_dpp v240, v240, v240 row_ror:4 row_mask:0xf bank_mask:0xf
    v_add_f32_dpp v241, v241, v241 row_ror:4 row_mask:0xf bank_mask:0xf
    s_nop 0
    v_add_f32_dpp v240, v240, v240 row_ror:8 row_mask:0xf bank_mask:0xf
    v_add_f32_dpp v241, v241, v241 row_ror:8 row_mask:0xf bank_mask:0xf

    s_mov_b32 exec_lo, 0x000f000f
    s_mov_b32 exec_hi, exec_lo
    v_pk_add_f32 v[240:241], v[240:241], v[18:19]
    v_cvt_pk_bf16_f32 v240, v240, v241
    global_store_dword v20, v240, s[72:73]

    s_cmp_lg_u32 s2, 0
    s_cbranch_scc1 L_fin
    s_mov_b64 exec, 1
    v_mov_b32 v50, s52
    v_mov_b32 v51, 0
    buffer_store_dword v50, v51, s[36:39], 0 offen

L_fin:
    s_endpgm
L_gr_22:
    s_sub_u32 s74, s74, 1
    s_cmp_lt_i32 s74, 0
    s_cbranch_scc1 L_gk_21
    ds_read_b32 v77, v11 offset:16
    ds_read_b128 v[64:67], v76 offset:17408
    ds_read_b128 v[68:71], v76 offset:21504
    ds_read_b128 v[72:75], v76 offset:25600
    s_branch L_gs_20
L_slow_23:
    s_mov_b32 s70, 200000
    v_or3_b32 v13, v80, v81, v82
    v_or_b32 v13, v13, v83
    v_and_b32 v13, 0x30003, v13
    s_nop 1
    v_or_b32_dpp v13, v13, v13 quad_perm:[1,0,3,2] row_mask:0xf bank_mask:0xf
    s_nop 1
    v_or_b32_dpp v13, v13, v13 quad_perm:[2,3,0,1] row_mask:0xf bank_mask:0xf
    v_cmp_ne_u32 s[8:9], 0, v13
    v_or3_b32 v13, v84, v85, v86
    v_or_b32 v13, v13, v87
    v_and_b32 v13, 0x30003, v13
    s_nop 1
    v_or_b32_dpp v13, v13, v13 quad_perm:[1,0,3,2] row_mask:0xf bank_mask:0xf
    s_nop 1
    v_or_b32_dpp v13, v13, v13 quad_perm:[2,3,0,1] row_mask:0xf bank_mask:0xf
    v_cmp_ne_u32 s[10:11], 0, v13
L_chk_24:
    s_mov_b64 exec, s[8:9]
    s_mov_b32 s53, 0
    buffer_load_dwordx4 v[80:83], v64, s[36:39], s53 offen sc1
    s_mov_b64 exec, s[10:11]
    s_mov_b32 s53, 114688
    buffer_load_dwordx4 v[84:87], v64, s[36:39], s53 offen sc1
    s_waitcnt vmcnt(0)
    s_mov_b64 exec, s[8:9]

    v_alignbit_b32 v88, v81, s44, 2
    v_lshl_add_u64 v[82:83], v[82:83], 0, v[66:67]
    v_alignbit_b32 v88, v80, v88, 3
    v_lshl_add_u64 v[80:81], v[80:81], 0, s[42:43]
    v_and_b32 v80, -4, v80
    v_and_b32 v81, -4, v81

    v_or3_b32 v13, v80, v81, v82
    v_or_b32 v13, v13, v83
    v_and_b32 v13, 0x30003, v13
    s_nop 1
    v_or_b32_dpp v13, v13, v13 quad_perm:[1,0,3,2] row_mask:0xf bank_mask:0xf
    s_nop 1
    v_or_b32_dpp v13, v13, v13 quad_perm:[2,3,0,1] row_mask:0xf bank_mask:0xf
    v_cmp_ne_u32 s[8:9], 0, v13
    s_mov_b64 exec, s[10:11]

    v_alignbit_b32 v89, v85, s44, 2
    v_lshl_add_u64 v[86:87], v[86:87], 0, v[66:67]
    v_alignbit_b32 v89, v84, v89, 3
    v_lshl_add_u64 v[84:85], v[84:85], 0, s[42:43]
    v_and_b32 v84, -4, v84
    v_and_b32 v85, -4, v85

    v_or3_b32 v13, v84, v85, v86
    v_or_b32 v13, v13, v87
    v_and_b32 v13, 0x30003, v13
    s_nop 1
    v_or_b32_dpp v13, v13, v13 quad_perm:[1,0,3,2] row_mask:0xf bank_mask:0xf
    s_nop 1
    v_or_b32_dpp v13, v13, v13 quad_perm:[2,3,0,1] row_mask:0xf bank_mask:0xf
    v_cmp_ne_u32 s[10:11], 0, v13
    s_or_b64 s[6:7], s[8:9], s[10:11]
    s_cselect_b32 s70, s70, 0
    s_sub_u32 s70, s70, 1
    s_cbranch_scc0 L_chk_24
    s_mov_b64 exec, -1
    v_fma_mix_f32 v96, v80, |v88|, v68 op_sel:[0,0,0] op_sel_hi:[1,0,0]
    v_fma_mix_f32 v97, v80, |v88|, v69 op_sel:[1,0,0] op_sel_hi:[1,0,0]
    v_fma_mix_f32 v98, v81, |v88|, v70 op_sel:[0,0,0] op_sel_hi:[1,0,0]
    v_fma_mix_f32 v99, v81, |v88|, v71 op_sel:[1,0,0] op_sel_hi:[1,0,0]
    v_fma_mix_f32 v100, v82, |v88|, v72 op_sel:[0,0,0] op_sel_hi:[1,0,0]
    v_fma_mix_f32 v101, v82, |v88|, v73 op_sel:[1,0,0] op_sel_hi:[1,0,0]
    v_fma_mix_f32 v102, v83, |v88|, v74 op_sel:[0,0,0] op_sel_hi:[1,0,0]
    v_fma_mix_f32 v103, v83, |v88|, v75 op_sel:[1,0,0] op_sel_hi:[1,0,0]
    v_fma_mix_f32 v96, v84, |v89|, v96 op_sel:[0,0,0] op_sel_hi:[1,0,0]
    v_fma_mix_f32 v97, v84, |v89|, v97 op_sel:[1,0,0] op_sel_hi:[1,0,0]
    v_fma_mix_f32 v98, v85, |v89|, v98 op_sel:[0,0,0] op_sel_hi:[1,0,0]
    v_fma_mix_f32 v99, v85, |v89|, v99 op_sel:[1,0,0] op_sel_hi:[1,0,0]
    v_fma_mix_f32 v100, v86, |v89|, v100 op_sel:[0,0,0] op_sel_hi:[1,0,0]
    v_fma_mix_f32 v101, v86, |v89|, v101 op_sel:[1,0,0] op_sel_hi:[1,0,0]
    v_fma_mix_f32 v102, v87, |v89|, v102 op_sel:[0,0,0] op_sel_hi:[1,0,0]
    v_fma_mix_f32 v103, v87, |v89|, v103 op_sel:[1,0,0] op_sel_hi:[1,0,0]
    s_nop 1
    s_branch L_ok_25
L_gr_32:
    s_sub_u32 s74, s74, 1
    s_cmp_lt_i32 s74, 0
    s_cbranch_scc1 L_gk_31
    ds_read_b32 v77, v11 offset:16
    ds_read_b128 v[64:67], v76 offset:17408
    ds_read_b128 v[68:71], v76 offset:21504
    ds_read_b128 v[72:75], v76 offset:25600
    s_branch L_gs_30
L_slow_33:
    s_mov_b32 s70, 200000
    v_or3_b32 v13, v80, v81, v82
    v_or_b32 v13, v13, v83
    v_and_b32 v13, 0x30003, v13
    s_nop 1
    v_or_b32_dpp v13, v13, v13 quad_perm:[1,0,3,2] row_mask:0xf bank_mask:0xf
    s_nop 1
    v_or_b32_dpp v13, v13, v13 quad_perm:[2,3,0,1] row_mask:0xf bank_mask:0xf
    v_cmp_ne_u32 s[8:9], 0, v13
    v_or3_b32 v13, v84, v85, v86
    v_or_b32 v13, v13, v87
    v_and_b32 v13, 0x30003, v13
    s_nop 1
    v_or_b32_dpp v13, v13, v13 quad_perm:[1,0,3,2] row_mask:0xf bank_mask:0xf
    s_nop 1
    v_or_b32_dpp v13, v13, v13 quad_perm:[2,3,0,1] row_mask:0xf bank_mask:0xf
    v_cmp_ne_u32 s[10:11], 0, v13
L_chk_34:
    s_mov_b64 exec, s[8:9]
    s_mov_b32 s53, 0
    buffer_load_dwordx4 v[80:83], v64, s[36:39], s53 offen sc1
    s_mov_b64 exec, s[10:11]
    s_mov_b32 s53, 114688
    buffer_load_dwordx4 v[84:87], v64, s[36:39], s53 offen sc1
    s_waitcnt vmcnt(0)
    s_mov_b64 exec, s[8:9]

    v_alignbit_b32 v88, v81, s44, 2
    v_lshl_add_u64 v[82:83], v[82:83], 0, v[66:67]
    v_alignbit_b32 v88, v80, v88, 3
    v_lshl_add_u64 v[80:81], v[80:81], 0, s[42:43]
    v_and_b32 v80, -4, v80
    v_and_b32 v81, -4, v81

    v_or3_b32 v13, v80, v81, v82
    v_or_b32 v13, v13, v83
    v_and_b32 v13, 0x30003, v13
    s_nop 1
    v_or_b32_dpp v13, v13, v13 quad_perm:[1,0,3,2] row_mask:0xf bank_mask:0xf
    s_nop 1
    v_or_b32_dpp v13, v13, v13 quad_perm:[2,3,0,1] row_mask:0xf bank_mask:0xf
    v_cmp_ne_u32 s[8:9], 0, v13
    s_mov_b64 exec, s[10:11]

    v_alignbit_b32 v89, v85, s44, 2
    v_lshl_add_u64 v[86:87], v[86:87], 0, v[66:67]
    v_alignbit_b32 v89, v84, v89, 3
    v_lshl_add_u64 v[84:85], v[84:85], 0, s[42:43]
    v_and_b32 v84, -4, v84
    v_and_b32 v85, -4, v85

    v_or3_b32 v13, v84, v85, v86
    v_or_b32 v13, v13, v87
    v_and_b32 v13, 0x30003, v13
    s_nop 1
    v_or_b32_dpp v13, v13, v13 quad_perm:[1,0,3,2] row_mask:0xf bank_mask:0xf
    s_nop 1
    v_or_b32_dpp v13, v13, v13 quad_perm:[2,3,0,1] row_mask:0xf bank_mask:0xf
    v_cmp_ne_u32 s[10:11], 0, v13
    s_or_b64 s[6:7], s[8:9], s[10:11]
    s_cselect_b32 s70, s70, 0
    s_sub_u32 s70, s70, 1
    s_cbranch_scc0 L_chk_34
    s_mov_b64 exec, -1
    v_fma_mix_f32 v96, v80, |v88|, v68 op_sel:[0,0,0] op_sel_hi:[1,0,0]
    v_fma_mix_f32 v97, v80, |v88|, v69 op_sel:[1,0,0] op_sel_hi:[1,0,0]
    v_fma_mix_f32 v98, v81, |v88|, v70 op_sel:[0,0,0] op_sel_hi:[1,0,0]
    v_fma_mix_f32 v99, v81, |v88|, v71 op_sel:[1,0,0] op_sel_hi:[1,0,0]
    v_fma_mix_f32 v100, v82, |v88|, v72 op_sel:[0,0,0] op_sel_hi:[1,0,0]
    v_fma_mix_f32 v101, v82, |v88|, v73 op_sel:[1,0,0] op_sel_hi:[1,0,0]
    v_fma_mix_f32 v102, v83, |v88|, v74 op_sel:[0,0,0] op_sel_hi:[1,0,0]
    v_fma_mix_f32 v103, v83, |v88|, v75 op_sel:[1,0,0] op_sel_hi:[1,0,0]
    v_fma_mix_f32 v96, v84, |v89|, v96 op_sel:[0,0,0] op_sel_hi:[1,0,0]
    v_fma_mix_f32 v97, v84, |v89|, v97 op_sel:[1,0,0] op_sel_hi:[1,0,0]
    v_fma_mix_f32 v98, v85, |v89|, v98 op_sel:[0,0,0] op_sel_hi:[1,0,0]
    v_fma_mix_f32 v99, v85, |v89|, v99 op_sel:[1,0,0] op_sel_hi:[1,0,0]
    v_fma_mix_f32 v100, v86, |v89|, v100 op_sel:[0,0,0] op_sel_hi:[1,0,0]
    v_fma_mix_f32 v101, v86, |v89|, v101 op_sel:[1,0,0] op_sel_hi:[1,0,0]
    v_fma_mix_f32 v102, v87, |v89|, v102 op_sel:[0,0,0] op_sel_hi:[1,0,0]
    v_fma_mix_f32 v103, v87, |v89|, v103 op_sel:[1,0,0] op_sel_hi:[1,0,0]
    s_nop 1
    s_branch L_ok_35
L_slow_43:
    s_mov_b32 s70, 200000
    v_or3_b32 v50, v160, v161, v162
    v_or_b32 v50, v50, v163
    v_and_b32 v50, 0x30003, v50
    s_nop 1
    v_or_b32_dpp v50, v50, v50 quad_perm:[1,0,3,2] row_mask:0xf bank_mask:0xf
    s_nop 1
    v_or_b32_dpp v50, v50, v50 quad_perm:[2,3,0,1] row_mask:0xf bank_mask:0xf
    v_cmp_ne_u32 s[8:9], 0, v50
    v_or3_b32 v50, v164, v165, v166
    v_or_b32 v50, v50, v167
    v_and_b32 v50, 0x30003, v50
    s_nop 1
    v_or_b32_dpp v50, v50, v50 quad_perm:[1,0,3,2] row_mask:0xf bank_mask:0xf
    s_nop 1
    v_or_b32_dpp v50, v50, v50 quad_perm:[2,3,0,1] row_mask:0xf bank_mask:0xf
    v_cmp_ne_u32 s[10:11], 0, v50
L_chk_44:
    s_mov_b64 exec, s[8:9]
    s_mov_b32 s53, 0
    buffer_load_dwordx4 v[160:163], v7, s[36:39], s53 offen sc1
    s_mov_b64 exec, s[10:11]
    s_mov_b32 s53, 131072
    buffer_load_dwordx4 v[164:167], v7, s[36:39], s53 offen sc1
    s_waitcnt vmcnt(0)
    s_mov_b64 exec, s[8:9]

    v_alignbit_b32 v236, v161, s32, 2
    v_lshl_add_u64 v[162:163], v[162:163], 0, v[228:229]
    v_alignbit_b32 v236, v160, v236, 3
    v_lshl_add_u64 v[160:161], v[160:161], 0, s[30:31]
    v_and_b32 v160, -4, v160
    v_and_b32 v161, -4, v161

    v_or3_b32 v50, v160, v161, v162
    v_or_b32 v50, v50, v163
    v_and_b32 v50, 0x30003, v50
    s_nop 1
    v_or_b32_dpp v50, v50, v50 quad_perm:[1,0,3,2] row_mask:0xf bank_mask:0xf
    s_nop 1
    v_or_b32_dpp v50, v50, v50 quad_perm:[2,3,0,1] row_mask:0xf bank_mask:0xf
    v_cmp_ne_u32 s[8:9], 0, v50
    s_mov_b64 exec, s[10:11]

    v_alignbit_b32 v237, v165, s32, 2
    v_lshl_add_u64 v[166:167], v[166:167], 0, v[228:229]
    v_alignbit_b32 v237, v164, v237, 3
    v_lshl_add_u64 v[164:165], v[164:165], 0, s[30:31]
    v_and_b32 v164, -4, v164
    v_and_b32 v165, -4, v165

    v_or3_b32 v50, v164, v165, v166
    v_or_b32 v50, v50, v167
    v_and_b32 v50, 0x30003, v50
    s_nop 1
    v_or_b32_dpp v50, v50, v50 quad_perm:[1,0,3,2] row_mask:0xf bank_mask:0xf
    s_nop 1
    v_or_b32_dpp v50, v50, v50 quad_perm:[2,3,0,1] row_mask:0xf bank_mask:0xf
    v_cmp_ne_u32 s[10:11], 0, v50
    s_or_b64 s[6:7], s[8:9], s[10:11]
    s_cselect_b32 s70, s70, 0
    s_sub_u32 s70, s70, 1
    s_cbranch_scc0 L_chk_44
    s_mov_b64 exec, -1
    v_fma_mix_f32 v240, v160, |v236|, 0 op_sel:[0,0,0] op_sel_hi:[1,0,0]
    v_fma_mix_f32 v241, v160, |v236|, 0 op_sel:[1,0,0] op_sel_hi:[1,0,0]
    v_fma_mix_f32 v242, v161, |v236|, 0 op_sel:[0,0,0] op_sel_hi:[1,0,0]
    v_fma_mix_f32 v243, v161, |v236|, 0 op_sel:[1,0,0] op_sel_hi:[1,0,0]
    v_fma_mix_f32 v244, v162, |v236|, 0 op_sel:[0,0,0] op_sel_hi:[1,0,0]
    v_fma_mix_f32 v245, v162, |v236|, 0 op_sel:[1,0,0] op_sel_hi:[1,0,0]
    v_fma_mix_f32 v246, v163, |v236|, 0 op_sel:[0,0,0] op_sel_hi:[1,0,0]
    v_fma_mix_f32 v247, v163, |v236|, 0 op_sel:[1,0,0] op_sel_hi:[1,0,0]
    v_fma_mix_f32 v240, v164, |v237|, v240 op_sel:[0,0,0] op_sel_hi:[1,0,0]
    v_fma_mix_f32 v241, v164, |v237|, v241 op_sel:[1,0,0] op_sel_hi:[1,0,0]
    v_fma_mix_f32 v242, v165, |v237|, v242 op_sel:[0,0,0] op_sel_hi:[1,0,0]
    v_fma_mix_f32 v243, v165, |v237|, v243 op_sel:[1,0,0] op_sel_hi:[1,0,0]
    v_fma_mix_f32 v244, v166, |v237|, v244 op_sel:[0,0,0] op_sel_hi:[1,0,0]
    v_fma_mix_f32 v245, v166, |v237|, v245 op_sel:[1,0,0] op_sel_hi:[1,0,0]
    v_fma_mix_f32 v246, v167, |v237|, v246 op_sel:[0,0,0] op_sel_hi:[1,0,0]
    v_fma_mix_f32 v247, v167, |v237|, v247 op_sel:[1,0,0] op_sel_hi:[1,0,0]
    s_nop 1
    s_branch L_ok_45
L_slow_53:
    s_mov_b32 s70, 200000
    s_mov_b64 exec, vcc
    v_or3_b32 v50, v232, v233, v234
    v_or_b32 v50, v50, v235
    v_cmp_ne_u32_sdwa s[8:9], 0, v50 src0_sel:DWORD src1_sel:BYTE_0
L_chk_54:
    s_mov_b64 exec, s[8:9]
    s_mov_b32 s53, 0
    buffer_load_dwordx4 v[232:235], v10, s[36:39], s53 offen sc1
    s_waitcnt vmcnt(0)
    s_mov_b64 exec, s[8:9]
    v_lshl_add_u64 v[232:233], v[232:233], 0, s[58:59]
    v_lshl_add_u64 v[234:235], v[234:235], 0, s[60:61]
    v_or3_b32 v50, v232, v233, v234
    v_or_b32 v50, v50, v235
    v_cmp_ne_u32_sdwa s[8:9], 0, v50 src0_sel:DWORD src1_sel:BYTE_0
    s_or_b64 s[6:7], s[8:9], s[8:9]
    s_cselect_b32 s70, s70, 0
    s_sub_u32 s70, s70, 1
    s_cbranch_scc0 L_chk_54
    s_mov_b64 exec, -1
    s_nop 1
    s_branch L_ok_55
L_far_76:
    buffer_store_dwordx4 v[52:55], v15, s[36:39], 0 offen sc1
    s_branch L_back_77
L_slow_91:
    s_mov_b32 s70, 200000
    v_or3_b32 v50, v160, v161, v162
    v_or_b32 v50, v50, v163
    v_and_b32 v50, 0x30003, v50
    s_nop 1
    v_or_b32_dpp v50, v50, v50 quad_perm:[1,0,3,2] row_mask:0xf bank_mask:0xf
    s_nop 1
    v_or_b32_dpp v50, v50, v50 quad_perm:[2,3,0,1] row_mask:0xf bank_mask:0xf
    v_cmp_ne_u32 s[8:9], 0, v50
L_chk_92:
    s_mov_b64 exec, s[8:9]
    s_mov_b32 s53, 0
    buffer_load_dwordx4 v[160:163], v9, s[36:39], s53 offen sc1
    s_waitcnt vmcnt(0)
    s_mov_b64 exec, s[8:9]

    v_alignbit_b32 v236, v161, s32, 2
    v_lshl_add_u64 v[162:163], v[162:163], 0, v[228:229]
    v_alignbit_b32 v236, v160, v236, 3
    v_lshl_add_u64 v[160:161], v[160:161], 0, s[30:31]
    v_and_b32 v160, -4, v160
    v_and_b32 v161, -4, v161

    v_or3_b32 v50, v160, v161, v162
    v_or_b32 v50, v50, v163
    v_and_b32 v50, 0x30003, v50
    s_nop 1
    v_or_b32_dpp v50, v50, v50 quad_perm:[1,0,3,2] row_mask:0xf bank_mask:0xf
    s_nop 1
    v_or_b32_dpp v50, v50, v50 quad_perm:[2,3,0,1] row_mask:0xf bank_mask:0xf
    v_cmp_ne_u32 s[8:9], 0, v50
    s_or_b64 s[6:7], s[8:9], s[8:9]
    s_cselect_b32 s70, s70, 0
    s_sub_u32 s70, s70, 1
    s_cbranch_scc0 L_chk_92
    s_mov_b64 exec, -1
    v_cndmask_b32 v244, v160, v162, s[40:41]
    v_cndmask_b32 v245, v161, v163, s[40:41]
    v_fma_mix_f32 v240, v244, |v236|, 0 op_sel:[0,0,0] op_sel_hi:[1,0,0]
    v_fma_mix_f32 v241, v244, |v236|, 0 op_sel:[1,0,0] op_sel_hi:[1,0,0]
    v_fma_mix_f32 v242, v245, |v236|, 0 op_sel:[0,0,0] op_sel_hi:[1,0,0]
    v_fma_mix_f32 v243, v245, |v236|, 0 op_sel:[1,0,0] op_sel_hi:[1,0,0]
    s_nop 1
    s_branch L_ok_93
L_far_94:
    buffer_store_dwordx4 v[52:55], v14, s[36:39], 0 offen sc1
    s_branch L_back_95
L_slow_96:
    v_or_b32_dpp v50, v50, v50 quad_perm:[1,0,3,2] row_mask:0xf bank_mask:0xf
    s_nop 1
    v_or_b32_dpp v50, v50, v50 quad_perm:[2,3,0,1] row_mask:0xf bank_mask:0xf
    v_cmp_ne_u32 vcc, 0, v50
    s_mov_b64 exec, vcc
    s_mov_b32 s53, 0
    buffer_load_dwordx4 v[160:163], v13, s[36:39], s53 offen sc1
    s_mov_b32 s53, 32768
    buffer_load_dwordx4 v[164:167], v13, s[36:39], s53 offen sc1
    s_sub_u32 s70, s70, 1
    s_cbranch_scc0 L_chk_97
    s_waitcnt vmcnt(0)
    s_branch L_ok_98
L_end:
    s_endpgm

.section .rodata,"a"
.p2align 6
.amdhsa_kernel parallel_sum__gqa_block_cached__dense_activation_squared_relu__decode_kernel
  .amdhsa_next_free_vgpr 256
  .amdhsa_next_free_sgpr 102
  .amdhsa_accum_offset 256
  .amdhsa_group_segment_fixed_size 0
  .amdhsa_kernarg_size 104
  .amdhsa_user_sgpr_count 2
  .amdhsa_user_sgpr_kernarg_segment_ptr 1
  .amdhsa_system_sgpr_workgroup_id_x 1
  .amdhsa_float_denorm_mode_32 3
  .amdhsa_float_denorm_mode_16_64 3
.end_amdhsa_kernel
```
